```python
import torch

def _softmax(x, axis=-1):
    return torch.softmax(x, dim=axis)
def _gelu(x):
    return torch.nn.functional.gelu(x, approximate="tanh")
def _silu(x):
    return torch.nn.functional.silu(x)
def _sigmoid(x):
    return torch.sigmoid(x)
def _layernorm(x, axis=-1, eps=1e-5):
    m = x.mean(dim=axis, keepdim=True)
    v = x.var(dim=axis, keepdim=True, unbiased=False)
    return (x - m) / torch.sqrt(v + eps)
def _scatter_add(tgt, idx, src, axis=0):
    return tgt.clone().index_add_(axis, idx, src)
def _segment_sum(src, seg, n):
    out = torch.zeros((n,) + src.shape[1:], dtype=src.dtype)
    return out.index_add_(0, seg, src)
def _pad(x, pw):
    flat = tuple(v for pair in reversed(pw) for v in pair)
    return torch.nn.functional.pad(x, flat)

kernel_name = 'concat_heads__compressed_kv_cla__sliding_block_cached__decode'

def setup_inputs():

    _w = (lambda a: (lambda t: t.to(torch.bfloat16) if t.is_floating_point() else t)(torch.as_tensor(a)))
    def _A_setup():
        B, H, Sq, Sk, D, M = 1, 32, 1, 16384, 128, 576
        Dc = 4 * D
        return {
            "x": _w((lambda *s: torch.randn(*s, dtype=torch.bfloat16) * 3.2)(B, Sq, M)),
            "c_kv": _w((lambda *s: torch.randn(*s, dtype=torch.bfloat16) * 0.1)(B, Sk, Dc)),
            "w_q": _w((lambda *s: torch.randn(*s, dtype=torch.bfloat16) * 6.4)(M, H, D) * (M ** -0.5)),
            "w_uk": _w((lambda *s: torch.randn(*s, dtype=torch.bfloat16) * 6.4)(Dc, H, D) * (Dc ** -0.5)),
            "w_uv": _w((lambda *s: torch.randn(*s, dtype=torch.bfloat16) * 0.1)(Dc, H, D) * (Dc ** -0.5)),
            "w_o": _w((lambda *s: torch.randn(*s, dtype=torch.bfloat16) * 0.1)(H, D, M) * ((H * D) ** -0.5)),
        }
    _A_in = _A_setup()

    def _B_setup():
        B, Sq, D = 1, 1, 576
        Hq, Hkv, Sk, Dh = 32, 16, 16384, 128
        assert Hq % Hkv == 0, (Hq, Hkv)
        return {
            "x": _w((lambda *s: torch.randn(*s, dtype=torch.bfloat16) * 1.6)(B, Sq, D)),
            "k_cache": _w((lambda *s: torch.randn(*s, dtype=torch.bfloat16) * 1.6)(B, Hkv, Sk, Dh)),
            "v_cache": _w((lambda *s: torch.randn(*s, dtype=torch.bfloat16) * 0.05)(B, Hkv, Sk, Dh)),
            "wq": _w((lambda *s: torch.randn(*s, dtype=torch.bfloat16) * 1.6)(D, Hq * Dh) * (D ** -0.5)),
            "wo": _w((lambda *s: torch.randn(*s, dtype=torch.bfloat16) * 0.05)(Hq * Dh, D) * ((Hq * Dh) ** -0.5)),
        }
    _B_in = _B_setup()

    return {
        "A_x": _A_in["x"],
        "A_c_kv": _A_in["c_kv"],
        "A_w_q": _A_in["w_q"],
        "A_w_uk": _A_in["w_uk"],
        "A_w_uv": _A_in["w_uv"],
        "A_w_o": _A_in["w_o"],
        "B_x": _B_in["x"],
        "B_k_cache": _B_in["k_cache"],
        "B_v_cache": _B_in["v_cache"],
        "B_wq": _B_in["wq"],
        "B_wo": _B_in["wo"],
    }

def reference(A_x, A_c_kv, A_w_q, A_w_uk, A_w_uv, A_w_o, B_x, B_k_cache, B_v_cache, B_wq, B_wo):
    def _A_ref(x, c_kv, w_q, w_uk, w_uv, w_o):
        B, Sq, M = x.shape[0], x.shape[1], x.shape[2]
        Sk = c_kv.shape[1]
        H, D = w_q.shape[1], w_q.shape[2]
        q = torch.einsum("bqm,mhd->bhqd", x, w_q)
        k = torch.einsum("bkc,chd->bhkd", c_kv, w_uk)
        v = torch.einsum("bkc,chd->bhkd", c_kv, w_uv)
        scores = torch.einsum("bhqd,bhkd->bhqk", q, k) * (D ** -0.5)
        off = Sk - Sq
        qi = torch.arange(Sq)[:, None]
        kj = torch.arange(Sk)[None, :]
        cmask = kj <= (qi + off)
        scores = torch.where(cmask[None, None], scores, -1e9)
        p = _softmax(scores, axis=-1)
        ctx = torch.einsum("bhqk,bhkd->bhqd", p, v)
        return torch.einsum("bhqd,hdm->bqm", ctx, w_o)

    def _B_ref(x, k_cache, v_cache, wq, wo):
        B, Sq, D = x.shape
        Hq, Dh = 32, 128
        Hkv, Sk = k_cache.shape[1], k_cache.shape[2]
        W = min(4096, max(256, Sk // 4))
        rep = Hq // Hkv
        q = (lambda x, *d: x.permute(*d))((x @ wq).reshape(B, Sq, Hq, Dh), 0, 2, 1, 3)
        k = (lambda x, n, axis: torch.repeat_interleave(x, n, dim=axis))(k_cache[:, :, Sk - W:, :], rep, axis=1)
        v = (lambda x, n, axis: torch.repeat_interleave(x, n, dim=axis))(v_cache[:, :, Sk - W:, :], rep, axis=1)
        scores = torch.einsum("bhqd,bhkd->bhqk", q, k) * (Dh ** -0.5)
        p = _softmax(scores, axis=-1)
        o = torch.einsum("bhqk,bhkd->bhqd", p, v)
        return (lambda x, *d: x.permute(*d))(o, 0, 2, 1, 3).reshape(B, Sq, Hq * Dh) @ wo

    a = _A_ref(A_x, A_c_kv, A_w_q, A_w_uk, A_w_uv, A_w_o)
    b = _B_ref(B_x, B_k_cache, B_v_cache, B_wq, B_wo)
    return torch.concatenate([a, b], axis=-1)
```

```asm
; @launch grid=(256,1,1) block=(256,1,1) lds=163840
.amdgcn_target "amdgcn-amd-amdhsa--gfx950"
.text
.globl concat_heads__compressed_kv_cla__sliding_block_cached__decode_kernel
.p2align 8
.type concat_heads__compressed_kv_cla__sliding_block_cached__decode_kernel,@function
concat_heads__compressed_kv_cla__sliding_block_cached__decode_kernel:
    s_cmp_lt_u32 s2, 128
    s_cselect_b32 s6, 16, 72
    s_load_dwordx2 s[8:9], s[0:1], s6
    s_cselect_b32 s7, 0, 48
    s_load_dwordx2 s[12:13], s[0:1], s7
    s_load_dwordx2 s[32:33], s[0:1], 104
    s_cmp_ge_u32 s2, 256
    s_cbranch_scc1 L_END
    v_lshrrev_b32 v8, 6, v0
    v_and_b32 v1, 63, v0
    v_readfirstlane_b32 s3, v8
    v_lshlrev_b32 v2, 4, v1
    s_getpc_b64 s[56:57]
L_PC:
    s_lshr_b32 s6, s2, 3
    s_lshl_b32 s6, s6, 10
    v_lshrrev_b32 v9, 5, v0
    v_lshl_add_u32 v9, v9, 7, s6
    v_min_u32 v9, L_CODE_END-L_PC-4, v9
    global_load_dword v12, v9, s[56:57]
    s_and_b32 s4, s2, 127
    v_and_b32 v8, 48, v1
    v_lshlrev_b32 v9, 1, v8
    v_lshlrev_b32 v8, 9, v8
    v_and_b32 v10, 0xf0, v2
    v_xor_b32 v9, v9, v10
    v_or_b32 v8, v8, v9
    v_and_b32 v9, 0x80, v0
    v_xor_b32 v14, v8, v9
    s_mov_b32 s10, 4718592
    s_mov_b32 s11, 0x20000
    s_and_b32 s58, s4, 3
    s_lshl_b32 s49, s58, 2
    s_add_u32 s49, s49, s3
    s_mul_i32 s48, s49, 294912
    s_lshr_b32 s49, s4, 2
    s_lshl_b32 s49, s49, 8
    s_add_u32 s48, s48, s49
    s_mul_i32 s59, s3, 9216
    s_add_u32 m0, s59, 126976
    s_waitcnt lgkmcnt(0)
    buffer_load_dwordx4 v14, s[8:11], s48 offen nt lds
    s_mulk_i32 s58, 288
    s_mov_b32 s49, 0x8000
    s_add_u32 m0, m0, 1024
    s_add_u32 s48, s48, s49
    v_add_u32 v9, 64, v0
    v_and_b32 v9, 0x80, v9
    v_xor_b32 v15, v8, v9
    buffer_load_dwordx4 v15, s[8:11], s48 offen nt lds
    s_add_u32 m0, m0, 1024
    s_add_u32 s48, s48, s49
    v_xor_b32 v16, 0x80, v14
    buffer_load_dwordx4 v16, s[8:11], s48 offen nt lds
    s_add_u32 m0, m0, 1024
    s_add_u32 s48, s48, s49
    v_xor_b32 v17, 0x80, v15
    buffer_load_dwordx4 v17, s[8:11], s48 offen nt lds
    s_add_u32 m0, m0, 1024
    s_add_u32 s48, s48, s49
    buffer_load_dwordx4 v14, s[8:11], s48 offen nt lds
    s_add_u32 m0, m0, 1024
    s_add_u32 s48, s48, s49
    buffer_load_dwordx4 v15, s[8:11], s48 offen nt lds
    s_add_u32 m0, m0, 1024
    s_add_u32 s48, s48, s49
    buffer_load_dwordx4 v16, s[8:11], s48 offen nt lds
    s_add_u32 m0, m0, 1024
    s_add_u32 s48, s48, s49
    buffer_load_dwordx4 v17, s[8:11], s48 offen nt lds
    s_add_u32 m0, m0, 1024
    s_add_u32 s48, s48, s49
    buffer_load_dwordx4 v14, s[8:11], s48 offen nt lds
    s_mov_b32 m0, 125952
    s_mov_b32 s14, 1152
    s_mov_b32 s15, 0x20000
    buffer_load_dwordx4 v2, s[12:15], s58 offen lds
    s_cmp_lt_u32 s2, 128
    s_cbranch_scc0 L_B_MAIN
    s_load_dword s5, s[32:33], 0
    s_load_dwordx2 s[16:17], s[0:1], 24
    s_load_dwordx2 s[20:21], s[0:1], 8
    s_load_dwordx2 s[28:29], s[0:1], 32
    s_load_dwordx2 s[24:25], s[0:1], 40
    s_load_dwordx2 s[36:37], s[0:1], 88
    s_mov_b32 s34, 16777216
    s_mov_b32 s35, 0x20000
    s_mov_b32 s18, 4194304
    s_mov_b32 s19, 0x20000
    s_mov_b32 s22, 16777216
    s_mov_b32 s23, 0x20000
    s_mov_b32 s30, 4194304
    s_mov_b32 s31, 0x20000
    s_mov_b32 s26, 4718592
    s_mov_b32 s27, 0x20000
    s_mov_b32 s38, 2304
    s_mov_b32 s39, 0x20000
    v_lshrrev_b32 v4, 4, v1
    v_and_b32 v5, 15, v1
    v_bfe_u32 v6, v1, 2, 2
    v_and_b32 v7, 3, v1
    s_mov_b32 s40, 0x07060500
    s_mov_b32 s41, 0x07060501
    s_mov_b32 s42, 0x07060502
    s_mov_b32 s43, 0x07060503
    s_mov_b32 s44, 0x0c0c0400
    s_mov_b32 s45, 0x04000c0c
    s_mov_b32 s46, 0x3e0293ee
    s_mov_b32 s51, 0xffffff00
    s_lshl_b32 s6, s4, 9
    s_lshl_b32 s7, s3, 7
    s_add_u32 s6, s6, s7
    s_add_u32 s6, s6, 458752
    v_lshl_add_u32 v8, v4, 4, s6
    v_lshl_add_u32 v8, v5, 6, v8
    v_cmp_gt_u32 vcc, 2, v5
    v_mov_b32 v11, 2130706432
    s_nop 0
    v_cndmask_b32 v18, v11, v8, vcc
    v_cmp_eq_u32 s[60:61], 1, v5
    v_lshlrev_b32 v20, 4, v4
    v_add_u32 v20, 125952, v20
    v_lshlrev_b32 v21, 3, v4
    v_add_u32 v21, 126208, v21
    v_and_b32 v10, 1, v4
    v_lshl_or_b32 v9, v10, 2, v6
    s_lshl_b32 s6, s3, 1
    v_xor_b32 v9, s6, v9
    v_lshlrev_b32 v9, 5, v9
    v_lshl_or_b32 v9, v7, 3, v9
    v_lshl_or_b32 v8, v4, 3, v6
    v_lshl_add_u32 v8, v8, 8, v9
    v_add_u32 v22, 126976, v8
    v_xor_b32 v23, 32, v22
    v_lshrrev_b32 v10, 1, v4
    v_lshl_or_b32 v9, v10, 2, v6
    v_xor_b32 v9, s6, v9
    v_lshlrev_b32 v9, 5, v9
    v_lshl_or_b32 v9, v7, 3, v9
    v_lshl_or_b32 v8, v4, 2, v6
    v_lshl_add_u32 v8, v8, 8, v9
    v_add_u32 v24, 159744, v8
    v_xor_b32 v25, 32, v24
    v_lshlrev_b32 v26, 6, v4
    v_lshl_or_b32 v26, v7, 4, v26
    s_lshl_b32 s63, s3, 15
    s_lshl_b32 s62, s4, 17
    s_mov_b32 s64, s63
    s_add_u32 s62, s62, s63
    s_lshl_b32 s6, s4, 2
    s_add_u32 s6, s6, s3
    s_lshr_b32 s7, s6, 2
    s_lshl_b32 s7, s7, 17
    s_and_b32 s6, s6, 3
    s_lshl_b32 s6, s6, 10
    s_add_u32 s62, s6, s7
    v_xor_b32 v33, 64, v2
    v_xor_b32 v34, 128, v2
    v_xor_b32 v35, 192, v2
    v_xor_b32 v36, 16, v2
    v_xor_b32 v37, 80, v2
    v_xor_b32 v38, 144, v2
    v_xor_b32 v39, 208, v2
    v_xor_b32 v40, 32, v2
    v_xor_b32 v41, 96, v2
    v_xor_b32 v42, 160, v2
    v_xor_b32 v43, 224, v2
    v_xor_b32 v44, 48, v2
    v_xor_b32 v45, 112, v2
    v_xor_b32 v46, 176, v2
    v_xor_b32 v47, 240, v2
    v_lshl_or_b32 v48, v6, 16, v26
    v_lshlrev_b32 v8, 9, v6
    v_lshl_or_b32 v8, v4, 7, v8
    v_lshl_or_b32 v8, v7, 5, v8
    s_lshr_b32 s6, s4, 2
    s_lshl_b32 s7, s6, 11
    s_add_u32 s7, s7, 458752
    v_add_u32 v19, s7, v8
    s_and_b32 s7, s4, 3
    s_lshl_b32 s49, s7, 2
    s_add_u32 s49, s49, s3
    s_lshl_b32 s65, s49, 18
    s_lshl_b32 s50, s6, 8
    s_add_u32 s65, s65, s50
    s_lshl_b32 s49, s49, 11
    s_lshl_b32 s50, s6, 4
    s_add_u32 s49, s49, s50
    s_add_u32 s49, s49, 65536
    v_lshl_add_u32 v8, v4, 9, s49
    v_cmp_eq_u32 vcc, 0, v5
    v_mov_b32 v11, 2130706432
    s_nop 0
    v_cndmask_b32 v49, v11, v8, vcc
    s_lshl_b32 s49, s7, 9
    s_add_u32 s49, s49, s50
    s_lshl_b32 s50, s3, 2
    s_add_u32 s49, s49, s50
    s_add_u32 s49, s49, 106496
    v_mov_b32 v8, s49
    v_cmp_eq_u32 vcc, 0, v1
    v_mov_b32 v11, 2130706432
    s_nop 0
    v_cndmask_b32 v51, v11, v8, vcc
    s_lshl_b32 s49, s3, 9
    s_add_u32 s49, s49, 106496
    v_lshl_add_u32 v52, v1, 3, s49
    s_lshl_b32 s7, s7, 11
    s_lshl_b32 s50, s6, 5
    s_add_u32 s7, s7, s50
    s_lshl_b32 s49, s3, 3
    s_add_u32 s7, s7, s49
    s_add_u32 s7, s7, 98304
    v_and_b32 v8, 1, v4
    v_lshl_add_u32 v8, v8, 10, s7
    v_lshrrev_b32 v9, 1, v4
    v_lshl_add_u32 v8, v9, 2, v8
    v_cmp_eq_u32 vcc, 0, v5
    v_mov_b32 v11, 2130706432
    s_nop 0
    v_cndmask_b32 v50, v11, v8, vcc
    s_waitcnt lgkmcnt(0)
    s_mul_i32 s5, s5, 1664525
    s_add_u32 s5, s5, 1013904223
    v_mov_b32 v3, s5
    s_mov_b32 s66, s65
    s_waitcnt vmcnt(8)
    buffer_load_dwordx4 a[0:3], v48, s[16:19], s65 offen nt
    s_add_u32 s65, s65, 8192
    s_waitcnt vmcnt(8)
    buffer_load_dwordx4 a[4:7], v48, s[16:19], s65 offen nt
    s_add_u32 s65, s65, 8192
    s_waitcnt vmcnt(8)
    buffer_load_dwordx4 a[8:11], v48, s[16:19], s65 offen nt
    s_add_u32 s65, s65, 8192
    s_waitcnt vmcnt(8)
    buffer_load_dwordx4 a[12:15], v48, s[16:19], s65 offen nt
    s_add_u32 s65, s65, 8192
    s_waitcnt vmcnt(4)
    s_barrier
    ds_read_b128 a[32:35], v20 offset:0
    ds_read_b64_tr_b16 a[52:53], v22 offset:0
    ds_read_b64_tr_b16 a[54:55], v22 offset:1024
    ds_read_b64_tr_b16 a[56:57], v23 offset:0
    ds_read_b64_tr_b16 a[58:59], v23 offset:1024
    ds_read_b128 a[36:39], v20 offset:64
    ds_read_b64_tr_b16 a[60:61], v22 offset:8192
    ds_read_b64_tr_b16 a[62:63], v22 offset:9216
    ds_read_b64_tr_b16 a[64:65], v23 offset:8192
    ds_read_b64_tr_b16 a[66:67], v23 offset:9216
    ds_read_b128 a[40:43], v20 offset:128
    ds_read_b64_tr_b16 a[68:69], v22 offset:16384
    ds_read_b64_tr_b16 a[70:71], v22 offset:17408
    ds_read_b64_tr_b16 a[72:73], v23 offset:16384
    ds_read_b64_tr_b16 a[74:75], v23 offset:17408
    s_waitcnt lgkmcnt(10)
    v_mfma_f32_16x16x32_bf16 v[64:67], a[52:55], a[32:35], 0
    v_mfma_f32_16x16x32_bf16 v[68:71], a[56:59], a[32:35], 0
    ds_read_b128 a[44:47], v20 offset:192
    ds_read_b64_tr_b16 a[76:77], v22 offset:24576
    ds_read_b64_tr_b16 a[78:79], v22 offset:25600
    ds_read_b64_tr_b16 a[80:81], v23 offset:24576
    ds_read_b64_tr_b16 a[82:83], v23 offset:25600
    s_waitcnt lgkmcnt(10)
    v_mfma_f32_16x16x32_bf16 v[64:67], a[60:63], a[36:39], v[64:67]
    v_mfma_f32_16x16x32_bf16 v[68:71], a[64:67], a[36:39], v[68:71]
    ds_read_b64 a[48:49], v21
    ds_read_b64_tr_b16 a[84:85], v24
    ds_read_b64_tr_b16 a[88:89], v25
    s_waitcnt lgkmcnt(8)
    v_mfma_f32_16x16x32_bf16 v[64:67], a[68:71], a[40:43], v[64:67]
    v_mfma_f32_16x16x32_bf16 v[68:71], a[72:75], a[40:43], v[68:71]
    s_waitcnt lgkmcnt(3)
    v_mfma_f32_16x16x32_bf16 v[64:67], a[76:79], a[44:47], v[64:67]
    v_mfma_f32_16x16x32_bf16 v[68:71], a[80:83], a[44:47], v[68:71]
    s_waitcnt lgkmcnt(0)
    v_mfma_f32_16x16x16_bf16 v[64:67], a[84:85], a[48:49], v[64:67]
    v_mfma_f32_16x16x16_bf16 v[68:71], a[88:89], a[48:49], v[68:71]
    s_nop 7
    v_cndmask_b32 v64, v64, v68, s[60:61]
    v_cndmask_b32 v65, v65, v69, s[60:61]
    v_cndmask_b32 v66, v66, v70, s[60:61]
    v_cndmask_b32 v67, v67, v71, s[60:61]
    v_perm_b32 v64, v64, v3, s40
    v_perm_b32 v65, v65, v3, s41
    v_perm_b32 v66, v66, v3, s42
    v_perm_b32 v67, v67, v3, s43
    buffer_store_dwordx4 v[64:67], v18, s[32:35], 0 offen sc1
    s_waitcnt vmcnt(9)
    buffer_load_dwordx4 a[16:19], v48, s[16:19], s65 offen nt
    s_add_u32 s65, s65, 8192
    s_waitcnt vmcnt(9)
    buffer_load_dwordx4 a[20:23], v48, s[16:19], s65 offen nt
    s_add_u32 s65, s65, 8192
    s_waitcnt vmcnt(9)
    buffer_load_dwordx4 a[24:27], v48, s[16:19], s65 offen nt
    s_add_u32 s65, s65, 8192
    s_waitcnt vmcnt(9)
    buffer_load_dwordx4 a[28:31], v48, s[16:19], s65 offen nt
    s_waitcnt vmcnt(8)
    s_add_u32 m0, s63, 0
    s_nop 0
    buffer_load_dwordx4 v2, s[20:23], s62 offen nt lds
    s_waitcnt vmcnt(8)
    s_add_u32 m0, s63, 1024
    s_add_u32 s62, s62, 4096
    buffer_load_dwordx4 v33, s[20:23], s62 offen nt lds
    s_waitcnt vmcnt(6)
    buffer_load_dwordx4 v[56:59], v19, s[32:35], 0 offen offset:0 sc1
    buffer_load_dwordx4 v[60:63], v19, s[32:35], 0 offen offset:16 sc1
    s_lshl_b32 s6, s3, 9
    s_lshl_b32 s7, s4, 11
    s_add_u32 s6, s6, s7
    s_add_u32 s6, s6, 131072
    v_and_b32 v8, 1, v7
    v_cmp_eq_u32 s[56:57], 1, v8
    v_and_b32 v9, 1, v6
    v_lshl_or_b32 v8, v9, 1, v8
    v_lshlrev_b32 v8, 3, v8
    v_and_b32 v9, 1, v4
    v_or_b32 v8, v8, v9
    v_lshrrev_b32 v9, 1, v6
    v_lshl_or_b32 v8, v9, 1, v8
    v_lshrrev_b32 v9, 1, v4
    v_lshl_or_b32 v8, v9, 2, v8
    v_lshlrev_b32 v8, 4, v8
    v_add_u32 v67, 131072, v8
    v_add_u32 v8, s6, v8
    v_cmp_gt_u32 vcc, 2, v7
    v_mov_b32 v11, 2130706432
    s_nop 0
    v_cndmask_b32 v64, v11, v8, vcc
    s_lshr_b32 s6, s4, 2
    s_lshl_b32 s6, s6, 11
    s_lshl_b32 s7, s3, 9
    s_add_u32 s6, s6, s7
    s_and_b32 s7, s4, 3
    s_lshl_b32 s7, s7, 7
    s_add_u32 s6, s6, s7
    s_add_u32 s6, s6, 393216
    v_lshl_add_u32 v8, v4, 4, s6
    v_lshl_add_u32 v8, v5, 6, v8
    v_cmp_gt_u32 vcc, 2, v5
    v_mov_b32 v11, 2130706432
    s_nop 0
    v_cndmask_b32 v65, v11, v8, vcc
    s_mul_i32 s6, s3, 6
    v_lshrrev_b32 v8, 3, v1
    v_add_u32 v8, s6, v8
    v_lshlrev_b32 v8, 14, v8
    v_and_b32 v9, 7, v1
    v_lshl_or_b32 v8, v9, 4, v8
    s_lshl_b32 s6, s4, 7
    s_add_u32 s6, s6, 524288
    v_add_u32 v8, s6, v8
    v_cmp_gt_u32 vcc, 3, v4
    v_mov_b32 v11, 2130706432
    s_nop 0
    v_cndmask_b32 v13, v11, v8, vcc
    s_lshl_b32 s7, s3, 11
    s_add_u32 s7, s7, 98304
    v_lshl_add_u32 v66, v1, 5, s7
    s_lshl_b32 s68, s3, 13
    s_add_u32 s67, s68, 65536
    s_add_u32 s68, s68, 131072
    v_lshlrev_b32 v96, 13, v4
    v_lshl_or_b32 v96, v5, 4, v96
    v_and_b32 v8, 31, v1
    v_lshlrev_b32 v95, 4, v8
    s_lshl_b32 s6, s3, 2
    v_add_u32 v94, s6, v95
    v_add_u32 v95, 131072, v95
    v_add_u32 v94, 131072, v94
    v_lshl_add_u32 v8, v8, 10, s63
    v_lshl_or_b32 v9, v7, 2, v6
    v_lshrrev_b32 v10, 5, v1
    v_xor_b32 v9, v9, v10
    v_lshl_or_b32 v68, v9, 4, v8
    v_xor_b32 v69, 32, v68
    v_xor_b32 v70, 64, v68
    v_xor_b32 v71, 96, v68
    v_xor_b32 v72, 128, v68
    v_xor_b32 v73, 160, v68
    v_xor_b32 v74, 192, v68
    v_xor_b32 v75, 224, v68
    v_add_u32 v76, 131072, v2
    v_lshl_or_b32 v8, v10, 2, v6
    v_lshlrev_b32 v8, 10, v8
    s_lshl_b32 s6, s3, 8
    v_or_b32 v8, s6, v8
    v_and_b32 v9, 1, v7
    v_lshl_or_b32 v8, v9, 3, v8
    v_and_b32 v9, 1, v4
    v_lshlrev_b32 v9, 1, v9
    v_lshrrev_b32 v11, 1, v7
    v_or_b32 v9, v9, v11
    v_lshl_or_b32 v11, v6, 2, v10
    v_xor_b32 v9, v9, v11
    v_lshl_or_b32 v78, v9, 4, v8
    v_xor_b32 v79, 8224, v78
    v_xor_b32 v80, 64, v78
    v_xor_b32 v81, 8288, v78
    v_xor_b32 v82, 128, v78
    v_xor_b32 v83, 8352, v78
    v_xor_b32 v84, 192, v78
    v_xor_b32 v85, 8416, v78
    v_add_u32 v86, 0x10000, v78
    v_add_u32 v87, 0x10000, v79
    v_add_u32 v88, 0x10000, v80
    v_add_u32 v89, 0x10000, v81
    v_add_u32 v90, 0x10000, v82
    v_add_u32 v91, 0x10000, v83
    v_add_u32 v92, 0x10000, v84
    v_add_u32 v93, 0x10000, v85
    s_lshl_b32 s6, s3, 11
    s_add_u32 s6, s6, 132096
    v_add_u32 v98, s6, v2
    v_and_b32 v8, 1, v4
    v_lshrrev_b32 v9, 1, v4
    v_lshl_or_b32 v8, v9, 2, v8
    v_lshrrev_b32 v9, 3, v5
    v_lshl_or_b32 v8, v9, 1, v8
    v_lshlrev_b32 v8, 17, v8
    v_and_b32 v9, 7, v5
    v_lshl_or_b32 v8, v9, 4, v8
    s_lshl_b32 s7, s4, 8
    s_add_u32 s6, s63, s7
    s_add_u32 s6, s6, 2097152
    v_add_u32 v97, s6, v8
    v_and_b32 v8, 1, v4
    v_lshlrev_b32 v8, 5, v8
    v_xor_b32 v8, v8, v2
    s_and_b32 s6, s3, 1
    s_lshl_b32 s6, s6, 7
    v_xor_b32 v8, s6, v8
    s_lshl_b32 s6, s3, 13
    v_add_u32 v100, s6, v8
    v_xor_b32 v101, 64, v100
    s_waitcnt vmcnt(10)
    s_add_u32 m0, s63, 2048
    s_add_u32 s62, s62, 4096
    buffer_load_dwordx4 v34, s[20:23], s62 offen nt lds
    s_waitcnt vmcnt(10)
    s_add_u32 m0, s63, 3072
    s_add_u32 s62, s62, 4096
    buffer_load_dwordx4 v35, s[20:23], s62 offen nt lds
    s_waitcnt vmcnt(9)
    s_add_u32 m0, s63, 4096
    s_add_u32 s62, s62, 4096
    buffer_load_dwordx4 v36, s[20:23], s62 offen nt lds
    s_waitcnt vmcnt(9)
    s_add_u32 m0, s63, 5120
    s_add_u32 s62, s62, 4096
    buffer_load_dwordx4 v37, s[20:23], s62 offen nt lds
    s_waitcnt vmcnt(9)
    s_add_u32 m0, s63, 6144
    s_add_u32 s62, s62, 4096
    buffer_load_dwordx4 v38, s[20:23], s62 offen nt lds
    s_waitcnt vmcnt(9)
    s_add_u32 m0, s63, 7168
    s_add_u32 s62, s62, 4096
    buffer_load_dwordx4 v39, s[20:23], s62 offen nt lds
    s_mov_b32 s47, 200000
    s_waitcnt vmcnt(6)
    s_branch L_c_2
L_r_1:
    buffer_load_dwordx4 v[56:59], v19, s[32:35], 0 offen offset:0 sc1
    buffer_load_dwordx4 v[60:63], v19, s[32:35], 0 offen offset:16 sc1
    s_waitcnt vmcnt(0)
L_c_2:
    v_perm_b32 v9, v57, v56, s44
    v_perm_b32 v10, v59, v58, s45
    v_bitop3_b32 v8, v9, v10, v3 bitop3:0x56
    v_perm_b32 v9, v61, v60, s44
    v_perm_b32 v10, v63, v62, s45
    v_bitop3_b32 v9, v9, v10, v3 bitop3:0x56
    v_or_b32 v8, v8, v9
    v_cmp_ne_u32 vcc, 0, v8
    s_nop 0
    s_cbranch_vccz L_o_3
    s_sub_u32 s47, s47, 1
    s_cmp_lg_u32 s47, 0
    s_cbranch_scc1 L_r_1
L_o_3:
    v_and_b32 v56, s51, v56
    v_and_b32 v57, s51, v57
    v_and_b32 v58, s51, v58
    v_and_b32 v59, s51, v59
    v_and_b32 v60, s51, v60
    v_and_b32 v61, s51, v61
    v_and_b32 v62, s51, v62
    v_and_b32 v63, s51, v63
    v_add_f32_dpp v56, v56, v56 row_ror:4 row_mask:0xf bank_mask:0xf
    v_add_f32_dpp v57, v57, v57 row_ror:4 row_mask:0xf bank_mask:0xf
    v_add_f32_dpp v58, v58, v58 row_ror:4 row_mask:0xf bank_mask:0xf
    v_add_f32_dpp v59, v59, v59 row_ror:4 row_mask:0xf bank_mask:0xf
    v_add_f32_dpp v60, v60, v60 row_ror:4 row_mask:0xf bank_mask:0xf
    v_add_f32_dpp v61, v61, v61 row_ror:4 row_mask:0xf bank_mask:0xf
    v_add_f32_dpp v62, v62, v62 row_ror:4 row_mask:0xf bank_mask:0xf
    v_add_f32_dpp v63, v63, v63 row_ror:4 row_mask:0xf bank_mask:0xf
    v_add_f32_dpp v56, v56, v56 row_ror:8 row_mask:0xf bank_mask:0xf
    v_add_f32_dpp v57, v57, v57 row_ror:8 row_mask:0xf bank_mask:0xf
    v_add_f32_dpp v58, v58, v58 row_ror:8 row_mask:0xf bank_mask:0xf
    v_add_f32_dpp v59, v59, v59 row_ror:8 row_mask:0xf bank_mask:0xf
    v_add_f32_dpp v60, v60, v60 row_ror:8 row_mask:0xf bank_mask:0xf
    v_add_f32_dpp v61, v61, v61 row_ror:8 row_mask:0xf bank_mask:0xf
    v_add_f32_dpp v62, v62, v62 row_ror:8 row_mask:0xf bank_mask:0xf
    v_add_f32_dpp v63, v63, v63 row_ror:8 row_mask:0xf bank_mask:0xf
    v_cvt_pk_bf16_f32 v28, v56, v57
    v_cvt_pk_bf16_f32 v29, v58, v59
    v_cvt_pk_bf16_f32 v30, v60, v61
    v_cvt_pk_bf16_f32 v31, v62, v63
    s_nop 1
    v_mfma_f32_16x16x32_bf16 v[104:107], a[0:3], v[28:31], 0
    v_mfma_f32_16x16x32_bf16 v[108:111], a[4:7], v[28:31], 0
    v_mfma_f32_16x16x32_bf16 v[112:115], a[8:11], v[28:31], 0
    v_mfma_f32_16x16x32_bf16 v[116:119], a[12:15], v[28:31], 0
    v_mfma_f32_16x16x32_bf16 v[120:123], a[16:19], v[28:31], 0
    v_mfma_f32_16x16x32_bf16 v[124:127], a[20:23], v[28:31], 0
    v_mfma_f32_16x16x32_bf16 v[128:131], a[24:27], v[28:31], 0
    v_mfma_f32_16x16x32_bf16 v[132:135], a[28:31], v[28:31], 0
    s_nop 0
    v_add_f32_dpp v104, v105, v104 quad_perm:[1,1,1,1] row_mask:0xf bank_mask:0xf
    v_add_f32_dpp v108, v109, v108 quad_perm:[1,1,1,1] row_mask:0xf bank_mask:0xf
    v_add_f32_dpp v112, v113, v112 quad_perm:[1,1,1,1] row_mask:0xf bank_mask:0xf
    v_add_f32_dpp v116, v117, v116 quad_perm:[1,1,1,1] row_mask:0xf bank_mask:0xf
    v_add_f32_dpp v120, v121, v120 quad_perm:[1,1,1,1] row_mask:0xf bank_mask:0xf
    v_add_f32_dpp v124, v125, v124 quad_perm:[1,1,1,1] row_mask:0xf bank_mask:0xf
    v_add_f32_dpp v128, v129, v128 quad_perm:[1,1,1,1] row_mask:0xf bank_mask:0xf
    v_add_f32_dpp v132, v133, v132 quad_perm:[1,1,1,1] row_mask:0xf bank_mask:0xf
    v_add_f32_dpp v104, v106, v104 quad_perm:[2,2,2,2] row_mask:0xf bank_mask:0xf
    v_add_f32_dpp v108, v110, v108 quad_perm:[2,2,2,2] row_mask:0xf bank_mask:0xf
    v_add_f32_dpp v112, v114, v112 quad_perm:[2,2,2,2] row_mask:0xf bank_mask:0xf
    v_add_f32_dpp v116, v118, v116 quad_perm:[2,2,2,2] row_mask:0xf bank_mask:0xf
    v_add_f32_dpp v120, v122, v120 quad_perm:[2,2,2,2] row_mask:0xf bank_mask:0xf
    v_add_f32_dpp v124, v126, v124 quad_perm:[2,2,2,2] row_mask:0xf bank_mask:0xf
    v_add_f32_dpp v128, v130, v128 quad_perm:[2,2,2,2] row_mask:0xf bank_mask:0xf
    v_add_f32_dpp v132, v134, v132 quad_perm:[2,2,2,2] row_mask:0xf bank_mask:0xf
    v_add_f32_dpp v104, v107, v104 quad_perm:[3,3,3,3] row_mask:0xf bank_mask:0xf
    v_add_f32_dpp v108, v111, v108 quad_perm:[3,3,3,3] row_mask:0xf bank_mask:0xf
    v_add_f32_dpp v112, v115, v112 quad_perm:[3,3,3,3] row_mask:0xf bank_mask:0xf
    v_add_f32_dpp v116, v119, v116 quad_perm:[3,3,3,3] row_mask:0xf bank_mask:0xf
    v_add_f32_dpp v120, v123, v120 quad_perm:[3,3,3,3] row_mask:0xf bank_mask:0xf
    v_add_f32_dpp v124, v127, v124 quad_perm:[3,3,3,3] row_mask:0xf bank_mask:0xf
    v_add_f32_dpp v128, v131, v128 quad_perm:[3,3,3,3] row_mask:0xf bank_mask:0xf
    v_add_f32_dpp v132, v135, v132 quad_perm:[3,3,3,3] row_mask:0xf bank_mask:0xf
    v_cvt_pk_bf16_f32 v136, v104, v108
    v_cvt_pk_bf16_f32 v137, v112, v116
    v_cvt_pk_bf16_f32 v138, v120, v124
    v_cvt_pk_bf16_f32 v139, v128, v132
    buffer_store_dwordx4 v[136:139], v49, s[32:35], 0 offen sc1
    v_add3_u32 v8, v136, v137, v138
    v_add_u32 v8, v8, v139
    v_sub_u32 v8, v3, v8
    buffer_store_dword v8, v50, s[32:35], 0 offen sc1
    buffer_store_dword v3, v51, s[32:35], 0 offen sc1
    s_waitcnt vmcnt(12)
    s_add_u32 m0, s63, 8192
    s_add_u32 s62, s62, 4096
    buffer_load_dwordx4 v40, s[20:23], s62 offen nt lds
    s_waitcnt vmcnt(12)
    s_add_u32 m0, s63, 9216
    s_add_u32 s62, s62, 4096
    buffer_load_dwordx4 v41, s[20:23], s62 offen nt lds
    s_waitcnt vmcnt(10)
    s_add_u32 m0, s63, 10240
    s_add_u32 s62, s62, 4096
    buffer_load_dwordx4 v42, s[20:23], s62 offen nt lds
    s_waitcnt vmcnt(10)
    s_add_u32 m0, s63, 11264
    s_add_u32 s62, s62, 4096
    buffer_load_dwordx4 v43, s[20:23], s62 offen nt lds
    s_waitcnt vmcnt(10)
    s_add_u32 m0, s63, 12288
    s_add_u32 s62, s62, 4096
    buffer_load_dwordx4 v44, s[20:23], s62 offen nt lds
    s_waitcnt vmcnt(10)
    s_add_u32 m0, s63, 13312
    s_add_u32 s62, s62, 4096
    buffer_load_dwordx4 v45, s[20:23], s62 offen nt lds
    s_waitcnt vmcnt(10)
    s_add_u32 m0, s63, 14336
    s_add_u32 s62, s62, 4096
    buffer_load_dwordx4 v46, s[20:23], s62 offen nt lds
    s_waitcnt vmcnt(10)
    s_add_u32 m0, s63, 15360
    s_add_u32 s62, s62, 4096
    buffer_load_dwordx4 v47, s[20:23], s62 offen nt lds
    s_waitcnt vmcnt(7)
    s_add_u32 m0, s63, 16384
    s_add_u32 s62, s62, 4096
    buffer_load_dwordx4 v2, s[20:23], s62 offen nt lds
    s_waitcnt vmcnt(7)
    s_add_u32 m0, s63, 17408
    s_add_u32 s62, s62, 4096
    buffer_load_dwordx4 v33, s[20:23], s62 offen nt lds
    s_waitcnt vmcnt(7)
    s_add_u32 m0, s63, 18432
    s_add_u32 s62, s62, 4096
    buffer_load_dwordx4 v34, s[20:23], s62 offen nt lds
    s_waitcnt vmcnt(7)
    s_add_u32 m0, s63, 19456
    s_add_u32 s62, s62, 4096
    buffer_load_dwordx4 v35, s[20:23], s62 offen nt lds
    s_waitcnt vmcnt(7)
    s_add_u32 m0, s63, 20480
    s_add_u32 s62, s62, 4096
    buffer_load_dwordx4 v36, s[20:23], s62 offen nt lds
    s_waitcnt vmcnt(7)
    s_add_u32 m0, s63, 21504
    s_add_u32 s62, s62, 4096
    buffer_load_dwordx4 v37, s[20:23], s62 offen nt lds
    s_waitcnt vmcnt(7)
    s_add_u32 m0, s63, 22528
    s_add_u32 s62, s62, 4096
    buffer_load_dwordx4 v38, s[20:23], s62 offen nt lds
    s_waitcnt vmcnt(7)
    s_add_u32 m0, s63, 23552
    s_add_u32 s62, s62, 4096
    buffer_load_dwordx4 v39, s[20:23], s62 offen nt lds
    s_waitcnt vmcnt(7)
    s_add_u32 m0, s63, 24576
    s_add_u32 s62, s62, 4096
    buffer_load_dwordx4 v40, s[20:23], s62 offen nt lds
    s_waitcnt vmcnt(7)
    s_add_u32 m0, s63, 25600
    s_add_u32 s62, s62, 4096
    buffer_load_dwordx4 v41, s[20:23], s62 offen nt lds
    s_waitcnt vmcnt(7)
    s_add_u32 m0, s63, 26624
    s_add_u32 s62, s62, 4096
    buffer_load_dwordx4 v42, s[20:23], s62 offen nt lds
    s_waitcnt vmcnt(7)
    s_add_u32 m0, s63, 27648
    s_add_u32 s62, s62, 4096
    buffer_load_dwordx4 v43, s[20:23], s62 offen nt lds
    s_waitcnt vmcnt(7)
    s_add_u32 m0, s63, 28672
    s_add_u32 s62, s62, 4096
    buffer_load_dwordx4 v44, s[20:23], s62 offen nt lds
    s_waitcnt vmcnt(7)
    s_add_u32 m0, s63, 29696
    s_add_u32 s62, s62, 4096
    buffer_load_dwordx4 v45, s[20:23], s62 offen nt lds
    s_waitcnt vmcnt(7)
    s_add_u32 m0, s63, 30720
    s_add_u32 s62, s62, 4096
    buffer_load_dwordx4 v46, s[20:23], s62 offen nt lds
    s_waitcnt vmcnt(7)
    s_add_u32 m0, s63, 31744
    s_add_u32 s62, s62, 4096
    buffer_load_dwordx4 v47, s[20:23], s62 offen nt lds
    s_mov_b32 m0, s68
    s_nop 0
    buffer_load_dwordx4 v2, s[32:35], s67 offen offset:0 sc1 lds
    buffer_load_dwordx4 v2, s[32:35], s67 offen offset:1024 sc1 lds
    buffer_load_dwordx4 v2, s[32:35], s67 offen offset:2048 sc1 lds
    buffer_load_dwordx4 v2, s[32:35], s67 offen offset:3072 sc1 lds
    s_add_u32 m0, s68, 4096
    s_add_u32 s6, s67, 4096
    buffer_load_dwordx4 v2, s[32:35], s6 offen offset:0 sc1 lds
    buffer_load_dwordx4 v2, s[32:35], s6 offen offset:1024 sc1 lds
    buffer_load_dwordx4 v2, s[32:35], s6 offen offset:2048 sc1 lds
    buffer_load_dwordx4 v2, s[32:35], s6 offen offset:3072 sc1 lds
    buffer_load_dwordx4 v[104:107], v66, s[32:35], 0 offen offset:0 sc1
    buffer_load_dwordx4 v[108:111], v66, s[32:35], 0 offen offset:16 sc1
    v_add_u32 v11, s68, v2
    s_mov_b32 s47, 200000
    s_waitcnt vmcnt(0)
    s_branch L_c_5
L_r_4:
L_h_7:
    s_sleep 8
    buffer_load_dwordx2 v[104:105], v52, s[32:35], 0 offen sc1
    s_waitcnt vmcnt(0)
    v_bitop3_b32 v8, v104, v105, v3 bitop3:0x7e
    v_cmp_ne_u32 vcc, 0, v8
    s_nop 0
    s_cbranch_vccz L_hx_8
    s_sub_u32 s47, s47, 1
    s_cmp_lg_u32 s47, 0
    s_cbranch_scc1 L_h_7
    s_mov_b32 s47, 1
L_hx_8:
    s_mov_b32 m0, s68
    s_nop 0
    buffer_load_dwordx4 v2, s[32:35], s67 offen offset:0 sc1 lds
    buffer_load_dwordx4 v2, s[32:35], s67 offen offset:1024 sc1 lds
    buffer_load_dwordx4 v2, s[32:35], s67 offen offset:2048 sc1 lds
    buffer_load_dwordx4 v2, s[32:35], s67 offen offset:3072 sc1 lds
    s_add_u32 m0, s68, 4096
    s_add_u32 s6, s67, 4096
    buffer_load_dwordx4 v2, s[32:35], s6 offen offset:0 sc1 lds
    buffer_load_dwordx4 v2, s[32:35], s6 offen offset:1024 sc1 lds
    buffer_load_dwordx4 v2, s[32:35], s6 offen offset:2048 sc1 lds
    buffer_load_dwordx4 v2, s[32:35], s6 offen offset:3072 sc1 lds
    buffer_load_dwordx4 v[104:107], v66, s[32:35], 0 offen offset:0 sc1
    buffer_load_dwordx4 v[108:111], v66, s[32:35], 0 offen offset:16 sc1
    s_waitcnt vmcnt(0)
L_c_5:
    ds_read_b128 v[112:115], v11 offset:0
    ds_read_b128 v[116:119], v11 offset:1024
    ds_read_b128 v[120:123], v11 offset:2048
    ds_read_b128 v[124:127], v11 offset:3072
    ds_read_b128 v[128:131], v11 offset:4096
    ds_read_b128 v[132:135], v11 offset:5120
    ds_read_b128 v[136:139], v11 offset:6144
    ds_read_b128 v[140:143], v11 offset:7168
    s_waitcnt lgkmcnt(7)
    v_add3_u32 v112, v112, v113, v114
    v_add3_u32 v112, v112, v115, v104
    s_waitcnt lgkmcnt(6)
    v_add3_u32 v116, v116, v117, v118
    v_add3_u32 v116, v116, v119, v105
    v_bitop3_b32 v116, v116, v112, v3 bitop3:0x7e
    s_waitcnt lgkmcnt(5)
    v_add3_u32 v120, v120, v121, v122
    v_add3_u32 v120, v120, v123, v106
    s_waitcnt lgkmcnt(4)
    v_add3_u32 v124, v124, v125, v126
    v_add3_u32 v124, v124, v127, v107
    v_bitop3_b32 v124, v124, v120, v3 bitop3:0x7e
    s_waitcnt lgkmcnt(3)
    v_add3_u32 v128, v128, v129, v130
    v_add3_u32 v128, v128, v131, v108
    s_waitcnt lgkmcnt(2)
    v_add3_u32 v132, v132, v133, v134
    v_add3_u32 v132, v132, v135, v109
    v_bitop3_b32 v132, v132, v128, v3 bitop3:0x7e
    s_waitcnt lgkmcnt(1)
    v_add3_u32 v136, v136, v137, v138
    v_add3_u32 v136, v136, v139, v110
    s_waitcnt lgkmcnt(0)
    v_add3_u32 v140, v140, v141, v142
    v_add3_u32 v140, v140, v143, v111
    v_bitop3_b32 v140, v140, v136, v3 bitop3:0x7e
    v_or3_b32 v8, v116, v124, v132
    v_or_b32 v8, v8, v140
    v_cmp_ne_u32 vcc, 0, v8
    s_nop 0
    s_cbranch_vccz L_o_6
    s_sub_u32 s47, s47, 1
    s_cmp_lg_u32 s47, 0
    s_cbranch_scc1 L_r_4
L_o_6:
    s_barrier
    s_mul_i32 s62, s4, 36864
    s_add_u32 s62, s62, s59
    s_add_u32 s6, s59, 65536
    v_add_u32 v120, s6, v2
    ds_read_b128 a[32:35], v68 offset:0
    ds_read_b128 a[56:59], v76 offset:0
    ds_read_b128 a[36:39], v69 offset:0
    ds_read_b128 a[60:63], v76 offset:1024
    ds_read_b128 a[40:43], v70 offset:0
    ds_read_b128 a[64:67], v76 offset:2048
    ds_read_b128 a[44:47], v71 offset:0
    ds_read_b128 a[68:71], v76 offset:3072
    ds_read_b128 a[48:51], v72 offset:0
    ds_read_b128 a[72:75], v76 offset:4096
    ds_read_b128 a[52:55], v73 offset:0
    ds_read_b128 a[76:79], v76 offset:5120
    s_waitcnt lgkmcnt(10)
    v_mfma_f32_32x32x16_bf16 v[104:119], a[32:35], a[56:59], 0
    ds_read_b128 a[32:35], v74 offset:0
    ds_read_b128 a[56:59], v76 offset:6144
    s_waitcnt lgkmcnt(10)
    v_mfma_f32_32x32x16_bf16 v[104:119], a[36:39], a[60:63], v[104:119]
    ds_read_b128 a[36:39], v75 offset:0
    ds_read_b128 a[60:63], v76 offset:7168
    s_waitcnt lgkmcnt(10)
    v_mfma_f32_32x32x16_bf16 v[104:119], a[40:43], a[64:67], v[104:119]
    ds_read_b128 a[40:43], v68 offset:256
    ds_read_b128 a[64:67], v76 offset:8192
    s_waitcnt lgkmcnt(10)
    v_mfma_f32_32x32x16_bf16 v[104:119], a[44:47], a[68:71], v[104:119]
    buffer_load_dwordx4 a[0:3], v96, s[28:31], s66 offen nt
    s_add_u32 s66, s66, 0x8000
    ds_read_b128 a[44:47], v69 offset:256
    ds_read_b128 a[68:71], v76 offset:9216
    s_waitcnt lgkmcnt(10)
    v_mfma_f32_32x32x16_bf16 v[104:119], a[48:51], a[72:75], v[104:119]
    ds_read_b128 a[48:51], v70 offset:256
    ds_read_b128 a[72:75], v76 offset:10240
    s_waitcnt lgkmcnt(10)
    v_mfma_f32_32x32x16_bf16 v[104:119], a[52:55], a[76:79], v[104:119]
    ds_read_b128 a[52:55], v71 offset:256
    ds_read_b128 a[76:79], v76 offset:11264
    s_waitcnt lgkmcnt(10)
    v_mfma_f32_32x32x16_bf16 v[104:119], a[32:35], a[56:59], v[104:119]
    ds_read_b128 a[32:35], v72 offset:256
    ds_read_b128 a[56:59], v76 offset:12288
    s_waitcnt lgkmcnt(10)
    v_mfma_f32_32x32x16_bf16 v[104:119], a[36:39], a[60:63], v[104:119]
    buffer_load_dwordx4 a[4:7], v96, s[28:31], s66 offen nt
    s_add_u32 s66, s66, 0x8000
    ds_read_b128 a[36:39], v73 offset:256
    ds_read_b128 a[60:63], v76 offset:13312
    s_waitcnt lgkmcnt(10)
    v_mfma_f32_32x32x16_bf16 v[104:119], a[40:43], a[64:67], v[104:119]
    ds_read_b128 a[40:43], v74 offset:256
    ds_read_b128 a[64:67], v76 offset:14336
    s_waitcnt lgkmcnt(10)
    v_mfma_f32_32x32x16_bf16 v[104:119], a[44:47], a[68:71], v[104:119]
    ds_read_b128 a[44:47], v75 offset:256
    ds_read_b128 a[68:71], v76 offset:15360
    s_waitcnt lgkmcnt(10)
    v_mfma_f32_32x32x16_bf16 v[104:119], a[48:51], a[72:75], v[104:119]
    ds_read_b128 a[48:51], v68 offset:512
    ds_read_b128 a[72:75], v76 offset:16384
    s_waitcnt lgkmcnt(10)
    v_mfma_f32_32x32x16_bf16 v[104:119], a[52:55], a[76:79], v[104:119]
    buffer_load_dwordx4 a[8:11], v96, s[28:31], s66 offen nt
    s_add_u32 s66, s66, 0x8000
    ds_read_b128 a[52:55], v69 offset:512
    ds_read_b128 a[76:79], v76 offset:17408
    s_waitcnt lgkmcnt(10)
    v_mfma_f32_32x32x16_bf16 v[104:119], a[32:35], a[56:59], v[104:119]
    ds_read_b128 a[32:35], v70 offset:512
    ds_read_b128 a[56:59], v76 offset:18432
    s_waitcnt lgkmcnt(10)
    v_mfma_f32_32x32x16_bf16 v[104:119], a[36:39], a[60:63], v[104:119]
    ds_read_b128 a[36:39], v71 offset:512
    ds_read_b128 a[60:63], v76 offset:19456
    s_waitcnt lgkmcnt(10)
    v_mfma_f32_32x32x16_bf16 v[104:119], a[40:43], a[64:67], v[104:119]
    ds_read_b128 a[40:43], v72 offset:512
    ds_read_b128 a[64:67], v76 offset:20480
    s_waitcnt lgkmcnt(10)
    v_mfma_f32_32x32x16_bf16 v[104:119], a[44:47], a[68:71], v[104:119]
    buffer_load_dwordx4 a[12:15], v96, s[28:31], s66 offen nt
    s_add_u32 s66, s66, 0x8000
    ds_read_b128 a[44:47], v73 offset:512
    ds_read_b128 a[68:71], v76 offset:21504
    s_waitcnt lgkmcnt(10)
    v_mfma_f32_32x32x16_bf16 v[104:119], a[48:51], a[72:75], v[104:119]
    ds_read_b128 a[48:51], v74 offset:512
    ds_read_b128 a[72:75], v76 offset:22528
    s_waitcnt lgkmcnt(10)
    v_mfma_f32_32x32x16_bf16 v[104:119], a[52:55], a[76:79], v[104:119]
    ds_read_b128 a[52:55], v75 offset:512
    ds_read_b128 a[76:79], v76 offset:23552
    s_waitcnt lgkmcnt(10)
    v_mfma_f32_32x32x16_bf16 v[104:119], a[32:35], a[56:59], v[104:119]
    ds_read_b128 a[32:35], v68 offset:768
    ds_read_b128 a[56:59], v76 offset:24576
    s_waitcnt lgkmcnt(10)
    v_mfma_f32_32x32x16_bf16 v[104:119], a[36:39], a[60:63], v[104:119]
    buffer_load_dwordx4 a[16:19], v96, s[28:31], s66 offen nt
    s_add_u32 s66, s66, 0x8000
    ds_read_b128 a[36:39], v69 offset:768
    ds_read_b128 a[60:63], v76 offset:25600
    s_waitcnt lgkmcnt(10)
    v_mfma_f32_32x32x16_bf16 v[104:119], a[40:43], a[64:67], v[104:119]
    ds_read_b128 a[40:43], v70 offset:768
    ds_read_b128 a[64:67], v76 offset:26624
    s_waitcnt lgkmcnt(10)
    v_mfma_f32_32x32x16_bf16 v[104:119], a[44:47], a[68:71], v[104:119]
    ds_read_b128 a[44:47], v71 offset:768
    ds_read_b128 a[68:71], v76 offset:27648
    s_waitcnt lgkmcnt(10)
    v_mfma_f32_32x32x16_bf16 v[104:119], a[48:51], a[72:75], v[104:119]
    ds_read_b128 a[48:51], v72 offset:768
    ds_read_b128 a[72:75], v76 offset:28672
    s_waitcnt lgkmcnt(10)
    v_mfma_f32_32x32x16_bf16 v[104:119], a[52:55], a[76:79], v[104:119]
    buffer_load_dwordx4 a[20:23], v96, s[28:31], s66 offen nt
    s_add_u32 s66, s66, 0x8000
    ds_read_b128 a[52:55], v73 offset:768
    ds_read_b128 a[76:79], v76 offset:29696
    s_waitcnt lgkmcnt(10)
    v_mfma_f32_32x32x16_bf16 v[104:119], a[32:35], a[56:59], v[104:119]
    ds_read_b128 a[32:35], v74 offset:768
    ds_read_b128 a[56:59], v76 offset:30720
    s_waitcnt lgkmcnt(10)
    v_mfma_f32_32x32x16_bf16 v[104:119], a[36:39], a[60:63], v[104:119]
    ds_read_b128 a[36:39], v75 offset:768
    ds_read_b128 a[60:63], v76 offset:31744
    s_waitcnt lgkmcnt(10)
    v_mfma_f32_32x32x16_bf16 v[104:119], a[40:43], a[64:67], v[104:119]
    s_waitcnt lgkmcnt(8)
    v_mfma_f32_32x32x16_bf16 v[104:119], a[44:47], a[68:71], v[104:119]
    buffer_load_dwordx4 a[24:27], v96, s[28:31], s66 offen nt
    s_add_u32 s66, s66, 0x8000
    s_waitcnt lgkmcnt(6)
    v_mfma_f32_32x32x16_bf16 v[104:119], a[48:51], a[72:75], v[104:119]
    s_waitcnt lgkmcnt(4)
    v_mfma_f32_32x32x16_bf16 v[104:119], a[52:55], a[76:79], v[104:119]
    s_waitcnt lgkmcnt(2)
    v_mfma_f32_32x32x16_bf16 v[104:119], a[32:35], a[56:59], v[104:119]
    s_waitcnt lgkmcnt(0)
    s_barrier
    v_mfma_f32_32x32x16_bf16 v[104:119], a[36:39], a[60:63], v[104:119]
    buffer_load_dwordx4 a[28:31], v96, s[28:31], s66 offen nt
    s_add_u32 s66, s66, 0x8000
    s_nop 9
    v_max3_f32 v8, v104, v105, v106
    v_max3_f32 v9, v107, v108, v109
    v_max3_f32 v10, v110, v111, v112
    v_max3_f32 v11, v113, v114, v115
    v_max3_f32 v8, v8, v116, v117
    v_max3_f32 v9, v9, v118, v119
    v_max3_f32 v8, v8, v9, v10
    v_max_f32 v121, v8, v11
    v_mov_b32 v8, v121
    s_nop 1
    v_permlane32_swap_b32 v121, v8
    v_max_f32 v121, v121, v8
    ds_write_b32 v94, v121
    s_waitcnt lgkmcnt(0)
    s_barrier
    ds_read_b128 v[124:127], v95
    s_waitcnt lgkmcnt(0)
    v_max3_f32 v8, v124, v125, v126
    v_max_f32 v8, v8, v127
    v_mul_f32 v140, s46, v8
    v_fma_f32 v104, v104, s46, -v140
    v_fma_f32 v105, v105, s46, -v140
    v_fma_f32 v106, v106, s46, -v140
    v_fma_f32 v107, v107, s46, -v140
    v_fma_f32 v108, v108, s46, -v140
    v_fma_f32 v109, v109, s46, -v140
    v_fma_f32 v110, v110, s46, -v140
    v_fma_f32 v111, v111, s46, -v140
    v_fma_f32 v112, v112, s46, -v140
    v_fma_f32 v113, v113, s46, -v140
    v_fma_f32 v114, v114, s46, -v140
    v_fma_f32 v115, v115, s46, -v140
    v_fma_f32 v116, v116, s46, -v140
    v_fma_f32 v117, v117, s46, -v140
    v_fma_f32 v118, v118, s46, -v140
    v_fma_f32 v119, v119, s46, -v140
    v_exp_f32 v104, v104
    v_exp_f32 v105, v105
    v_exp_f32 v106, v106
    v_exp_f32 v107, v107
    v_exp_f32 v108, v108
    v_exp_f32 v109, v109
    v_exp_f32 v110, v110
    v_exp_f32 v111, v111
    v_exp_f32 v112, v112
    v_exp_f32 v113, v113
    v_exp_f32 v114, v114
    v_exp_f32 v115, v115
    v_exp_f32 v116, v116
    v_exp_f32 v117, v117
    v_exp_f32 v118, v118
    v_exp_f32 v119, v119
    v_cvt_pk_bf16_f32 v132, v104, v105
    v_cvt_pk_bf16_f32 v133, v106, v107
    v_cvt_pk_bf16_f32 v134, v108, v109
    v_cvt_pk_bf16_f32 v135, v110, v111
    v_cvt_pk_bf16_f32 v136, v112, v113
    v_cvt_pk_bf16_f32 v137, v114, v115
    v_cvt_pk_bf16_f32 v138, v116, v117
    v_cvt_pk_bf16_f32 v139, v118, v119
    ds_write_b128 v98, v[132:135]
    ds_write_b128 v98, v[136:139] offset:1024
    ds_read_b64_tr_b16 a[148:149], v78 offset:0
    ds_read_b64_tr_b16 a[150:151], v79 offset:0
    ds_read_b64_tr_b16 a[152:153], v80 offset:0
    ds_read_b64_tr_b16 a[154:155], v81 offset:0
    ds_read_b64_tr_b16 a[156:157], v78 offset:16384
    ds_read_b64_tr_b16 a[158:159], v79 offset:16384
    ds_read_b64_tr_b16 a[160:161], v80 offset:16384
    ds_read_b64_tr_b16 a[162:163], v81 offset:16384
    ds_read_b64_tr_b16 a[164:165], v78 offset:32768
    ds_read_b64_tr_b16 a[166:167], v79 offset:32768
    s_waitcnt lgkmcnt(10)
    s_barrier
    ds_read_b128 a[116:119], v76 offset:1024
    ds_read_b128 a[120:123], v76 offset:2048
    ds_read_b128 a[124:127], v76 offset:3072
    ds_read_b64_tr_b16 a[168:169], v80 offset:32768
    ds_read_b64_tr_b16 a[170:171], v81 offset:32768
    s_waitcnt lgkmcnt(4)
    v_mfma_f32_32x32x16_bf16 v[144:159], a[116:119], a[148:151], 0
    v_add_f32 v104, v104, v112
    v_add_f32 v105, v105, v113
    v_add_f32 v106, v106, v114
    ds_read_b128 a[128:131], v76 offset:4096
    ds_read_b64_tr_b16 a[172:173], v78 offset:49152
    ds_read_b64_tr_b16 a[174:175], v79 offset:49152
    s_waitcnt lgkmcnt(7)
    v_mfma_f32_32x32x16_bf16 v[160:175], a[116:119], a[152:155], 0
    v_add_f32 v107, v107, v115
    v_add_f32 v108, v108, v116
    v_add_f32 v109, v109, v117
    ds_read_b64_tr_b16 a[148:149], v80 offset:49152
    ds_read_b64_tr_b16 a[150:151], v81 offset:49152
    s_waitcnt lgkmcnt(8)
    v_mfma_f32_32x32x16_bf16 v[144:159], a[120:123], a[156:159], v[144:159]
    v_add_f32 v110, v110, v118
    v_add_f32 v111, v111, v119
    v_add_f32 v104, v104, v108
    ds_read_b128 a[132:135], v76 offset:5120
    ds_read_b64_tr_b16 a[152:153], v86 offset:0
    ds_read_b64_tr_b16 a[154:155], v87 offset:0
    s_waitcnt lgkmcnt(11)
    v_mfma_f32_32x32x16_bf16 v[160:175], a[120:123], a[160:163], v[160:175]
    v_add_f32 v105, v105, v109
    v_add_f32 v106, v106, v110
    v_add_f32 v107, v107, v111
    ds_read_b64_tr_b16 a[156:157], v88 offset:0
    ds_read_b64_tr_b16 a[158:159], v89 offset:0
    s_waitcnt lgkmcnt(12)
    v_mfma_f32_32x32x16_bf16 v[144:159], a[124:127], a[164:167], v[144:159]
    v_add_f32 v104, v104, v106
    v_add_f32 v105, v105, v107
    v_add_f32 v104, v104, v105
    ds_read_b128 a[136:139], v76 offset:6144
    ds_read_b64_tr_b16 a[160:161], v86 offset:16384
    ds_read_b64_tr_b16 a[162:163], v87 offset:16384
    s_waitcnt lgkmcnt(13)
    v_mfma_f32_32x32x16_bf16 v[160:175], a[124:127], a[168:171], v[160:175]
    v_mov_b32 v8, v104
    s_nop 1
    v_permlane32_swap_b32 v104, v8
    v_add_f32 v128, v104, v8
    ds_read_b64_tr_b16 a[164:165], v88 offset:16384
    ds_read_b64_tr_b16 a[166:167], v89 offset:16384
    s_waitcnt lgkmcnt(12)
    v_mfma_f32_32x32x16_bf16 v[144:159], a[128:131], a[172:175], v[144:159]
    ds_read_b128 a[140:143], v76 offset:7168
    ds_read_b64_tr_b16 a[168:169], v86 offset:32768
    ds_read_b64_tr_b16 a[170:171], v87 offset:32768
    s_waitcnt lgkmcnt(13)
    v_mfma_f32_32x32x16_bf16 v[160:175], a[128:131], a[148:151], v[160:175]
    ds_read_b64_tr_b16 a[172:173], v88 offset:32768
    ds_read_b64_tr_b16 a[174:175], v89 offset:32768
    s_waitcnt lgkmcnt(12)
    v_mfma_f32_32x32x16_bf16 v[144:159], a[132:135], a[152:155], v[144:159]
    ds_write_b32 v94, v128 offset:512
    ds_read_b128 a[144:147], v76 offset:8192
    ds_read_b64_tr_b16 a[148:149], v86 offset:49152
    ds_read_b64_tr_b16 a[150:151], v87 offset:49152
    s_waitcnt lgkmcnt(14)
    v_mfma_f32_32x32x16_bf16 v[160:175], a[132:135], a[156:159], v[160:175]
    ds_read_b64_tr_b16 a[152:153], v88 offset:49152
    ds_read_b64_tr_b16 a[154:155], v89 offset:49152
    s_waitcnt lgkmcnt(13)
    v_mfma_f32_32x32x16_bf16 v[144:159], a[136:139], a[160:163], v[144:159]
    ds_read_b64_tr_b16 a[156:157], v82 offset:0
    ds_read_b64_tr_b16 a[158:159], v83 offset:0
    s_waitcnt lgkmcnt(13)
    v_mfma_f32_32x32x16_bf16 v[160:175], a[136:139], a[164:167], v[160:175]
    ds_read_b64_tr_b16 a[160:161], v84 offset:0
    ds_read_b64_tr_b16 a[162:163], v85 offset:0
    s_waitcnt lgkmcnt(12)
    v_mfma_f32_32x32x16_bf16 v[144:159], a[140:143], a[168:171], v[144:159]
    ds_read_b64_tr_b16 a[164:165], v82 offset:16384
    ds_read_b64_tr_b16 a[166:167], v83 offset:16384
    s_waitcnt lgkmcnt(12)
    v_mfma_f32_32x32x16_bf16 v[160:175], a[140:143], a[172:175], v[160:175]
    ds_read_b64_tr_b16 a[168:169], v84 offset:16384
    ds_read_b64_tr_b16 a[170:171], v85 offset:16384
    s_waitcnt lgkmcnt(10)
    v_mfma_f32_32x32x16_bf16 v[144:159], a[144:147], a[148:151], v[144:159]
    ds_read_b64_tr_b16 a[172:173], v82 offset:32768
    ds_read_b64_tr_b16 a[174:175], v83 offset:32768
    s_waitcnt lgkmcnt(10)
    v_mfma_f32_32x32x16_bf16 v[160:175], a[144:147], a[152:155], v[160:175]
    ds_read_b64_tr_b16 a[148:149], v84 offset:32768
    ds_read_b64_tr_b16 a[150:151], v85 offset:32768
    s_waitcnt lgkmcnt(10)
    v_mfma_f32_32x32x16_bf16 v[176:191], a[116:119], a[156:159], 0
    ds_read_b64_tr_b16 a[152:153], v82 offset:49152
    ds_read_b64_tr_b16 a[154:155], v83 offset:49152
    s_waitcnt lgkmcnt(10)
    v_mfma_f32_32x32x16_bf16 v[192:207], a[116:119], a[160:163], 0
    ds_read_b64_tr_b16 a[156:157], v84 offset:49152
    ds_read_b64_tr_b16 a[158:159], v85 offset:49152
    s_waitcnt lgkmcnt(10)
    v_mfma_f32_32x32x16_bf16 v[176:191], a[120:123], a[164:167], v[176:191]
    v_cvt_pk_bf16_f32 v208, v144, v160
    v_cvt_pk_bf16_f32 v209, v145, v161
    v_cvt_pk_bf16_f32 v210, v146, v162
    v_cvt_pk_bf16_f32 v211, v147, v163
    v_cvt_pk_bf16_f32 v212, v148, v164
    ds_read_b64_tr_b16 a[160:161], v90 offset:0
    ds_read_b64_tr_b16 a[162:163], v91 offset:0
    s_waitcnt lgkmcnt(10)
    v_mfma_f32_32x32x16_bf16 v[192:207], a[120:123], a[168:171], v[192:207]
    v_cvt_pk_bf16_f32 v213, v149, v165
    v_cvt_pk_bf16_f32 v214, v150, v166
    v_cvt_pk_bf16_f32 v215, v151, v167
    v_permlane16_swap_b32 v208, v209
    v_permlane16_swap_b32 v210, v211
    ds_read_b64_tr_b16 a[164:165], v92 offset:0
    ds_read_b64_tr_b16 a[166:167], v93 offset:0
    s_waitcnt lgkmcnt(10)
    v_mfma_f32_32x32x16_bf16 v[176:191], a[124:127], a[172:175], v[176:191]
    s_mov_b32 s48, 0
    v_mov_b32 v224, v208
    v_mov_b32 v225, v209
    v_mov_b32_dpp v208, v210 row_ror:8 row_mask:0xf bank_mask:0xc
    v_mov_b32_dpp v209, v211 row_ror:8 row_mask:0xf bank_mask:0xc
    ds_read_b64_tr_b16 a[168:169], v90 offset:16384
    ds_read_b64_tr_b16 a[170:171], v91 offset:16384
    s_waitcnt lgkmcnt(10)
    v_mfma_f32_32x32x16_bf16 v[192:207], a[124:127], a[148:151], v[192:207]
    v_mov_b32_dpp v210, v224 row_ror:8 row_mask:0xf bank_mask:0x3
    v_mov_b32_dpp v211, v225 row_ror:8 row_mask:0xf bank_mask:0x3
    buffer_store_dwordx4 v[208:211], v97, s[32:35], s48 offen offset:0 sc1
    v_add3_u32 v226, v208, v209, 0
    v_add3_u32 v226, v210, v211, v226
    ds_read_b64_tr_b16 a[172:173], v92 offset:16384
    ds_read_b64_tr_b16 a[174:175], v93 offset:16384
    s_waitcnt lgkmcnt(10)
    v_mfma_f32_32x32x16_bf16 v[176:191], a[128:131], a[152:155], v[176:191]
    v_cvt_pk_bf16_f32 v216, v152, v168
    v_cvt_pk_bf16_f32 v217, v153, v169
    v_cvt_pk_bf16_f32 v218, v154, v170
    v_cvt_pk_bf16_f32 v219, v155, v171
    v_permlane16_swap_b32 v212, v213
    ds_read_b64_tr_b16 a[148:149], v90 offset:32768
    ds_read_b64_tr_b16 a[150:151], v91 offset:32768
    s_waitcnt lgkmcnt(10)
    v_mfma_f32_32x32x16_bf16 v[192:207], a[128:131], a[156:159], v[192:207]
    v_permlane16_swap_b32 v214, v215
    s_mov_b32 s48, 1048576
    v_mov_b32 v224, v212
    v_mov_b32 v225, v213
    v_mov_b32_dpp v212, v214 row_ror:8 row_mask:0xf bank_mask:0xc
    ds_read_b64_tr_b16 a[152:153], v92 offset:32768
    ds_read_b64_tr_b16 a[154:155], v93 offset:32768
    s_waitcnt lgkmcnt(10)
    v_mfma_f32_32x32x16_bf16 v[176:191], a[132:135], a[160:163], v[176:191]
    v_mov_b32_dpp v213, v215 row_ror:8 row_mask:0xf bank_mask:0xc
    v_mov_b32_dpp v214, v224 row_ror:8 row_mask:0xf bank_mask:0x3
    v_mov_b32_dpp v215, v225 row_ror:8 row_mask:0xf bank_mask:0x3
    buffer_store_dwordx4 v[212:215], v97, s[32:35], s48 offen offset:0 sc1
    v_add3_u32 v227, v212, v213, 0
    ds_read_b64_tr_b16 a[156:157], v90 offset:49152
    ds_read_b64_tr_b16 a[158:159], v91 offset:49152
    s_waitcnt lgkmcnt(10)
    v_mfma_f32_32x32x16_bf16 v[192:207], a[132:135], a[164:167], v[192:207]
    v_add3_u32 v227, v214, v215, v227
    v_cvt_pk_bf16_f32 v220, v156, v172
    v_cvt_pk_bf16_f32 v221, v157, v173
    v_cvt_pk_bf16_f32 v222, v158, v174
    v_cvt_pk_bf16_f32 v223, v159, v175
    ds_read_b64_tr_b16 a[160:161], v92 offset:49152
    ds_read_b64_tr_b16 a[162:163], v93 offset:49152
    s_waitcnt lgkmcnt(10)
    v_mfma_f32_32x32x16_bf16 v[176:191], a[136:139], a[168:171], v[176:191]
    v_permlane16_swap_b32 v216, v217
    v_permlane16_swap_b32 v218, v219
    s_mov_b32 s48, 2097152
    v_mov_b32 v224, v216
    v_mov_b32 v225, v217
    s_waitcnt lgkmcnt(8)
    v_mfma_f32_32x32x16_bf16 v[192:207], a[136:139], a[172:175], v[192:207]
    v_mov_b32_dpp v216, v218 row_ror:8 row_mask:0xf bank_mask:0xc
    v_mov_b32_dpp v217, v219 row_ror:8 row_mask:0xf bank_mask:0xc
    v_mov_b32_dpp v218, v224 row_ror:8 row_mask:0xf bank_mask:0x3
    v_mov_b32_dpp v219, v225 row_ror:8 row_mask:0xf bank_mask:0x3
    buffer_store_dwordx4 v[216:219], v97, s[32:35], s48 offen offset:0 sc1
    s_waitcnt lgkmcnt(6)
    v_mfma_f32_32x32x16_bf16 v[176:191], a[140:143], a[148:151], v[176:191]
    v_add3_u32 v228, v216, v217, 0
    v_add3_u32 v228, v218, v219, v228
    v_permlane16_swap_b32 v220, v221
    v_permlane16_swap_b32 v222, v223
    s_mov_b32 s48, 3145728
    s_waitcnt lgkmcnt(4)
    v_mfma_f32_32x32x16_bf16 v[192:207], a[140:143], a[152:155], v[192:207]
    v_mov_b32 v224, v220
    v_mov_b32 v225, v221
    v_mov_b32_dpp v220, v222 row_ror:8 row_mask:0xf bank_mask:0xc
    v_mov_b32_dpp v221, v223 row_ror:8 row_mask:0xf bank_mask:0xc
    v_mov_b32_dpp v222, v224 row_ror:8 row_mask:0xf bank_mask:0x3
    s_waitcnt lgkmcnt(2)
    v_mfma_f32_32x32x16_bf16 v[176:191], a[144:147], a[156:159], v[176:191]
    v_mov_b32_dpp v223, v225 row_ror:8 row_mask:0xf bank_mask:0x3
    buffer_store_dwordx4 v[220:223], v97, s[32:35], s48 offen offset:0 sc1
    v_add3_u32 v229, v220, v221, 0
    v_add3_u32 v229, v222, v223, v229
    s_waitcnt lgkmcnt(0)
    v_mfma_f32_32x32x16_bf16 v[192:207], a[144:147], a[160:163], v[192:207]
    s_barrier
    ds_read_b128 v[232:235], v67
    ds_read_b128 v[124:127], v67 offset:512
    s_nop 8
    v_cvt_pk_bf16_f32 v208, v176, v192
    v_cvt_pk_bf16_f32 v209, v177, v193
    v_cvt_pk_bf16_f32 v210, v178, v194
    v_cvt_pk_bf16_f32 v211, v179, v195
    v_cvt_pk_bf16_f32 v212, v180, v196
    v_cvt_pk_bf16_f32 v213, v181, v197
    v_cvt_pk_bf16_f32 v214, v182, v198
    v_cvt_pk_bf16_f32 v215, v183, v199
    v_permlane16_swap_b32 v208, v209
    v_permlane16_swap_b32 v210, v211
    s_mov_b32 s48, 0
    v_mov_b32 v224, v208
    v_mov_b32 v225, v209
    v_mov_b32_dpp v208, v210 row_ror:8 row_mask:0xf bank_mask:0xc
    v_mov_b32_dpp v209, v211 row_ror:8 row_mask:0xf bank_mask:0xc
    v_mov_b32_dpp v210, v224 row_ror:8 row_mask:0xf bank_mask:0x3
    v_mov_b32_dpp v211, v225 row_ror:8 row_mask:0xf bank_mask:0x3
    buffer_store_dwordx4 v[208:211], v97, s[32:35], s48 offen offset:128 sc1
    v_add3_u32 v226, v208, v209, v226
    v_add3_u32 v226, v210, v211, v226
    v_cvt_pk_bf16_f32 v216, v184, v200
    v_cvt_pk_bf16_f32 v217, v185, v201
    v_cvt_pk_bf16_f32 v218, v186, v202
    v_cvt_pk_bf16_f32 v219, v187, v203
    v_permlane16_swap_b32 v212, v213
    v_permlane16_swap_b32 v214, v215
    s_mov_b32 s48, 1048576
    v_mov_b32 v224, v212
    v_mov_b32 v225, v213
    v_mov_b32_dpp v212, v214 row_ror:8 row_mask:0xf bank_mask:0xc
    v_mov_b32_dpp v213, v215 row_ror:8 row_mask:0xf bank_mask:0xc
    v_mov_b32_dpp v214, v224 row_ror:8 row_mask:0xf bank_mask:0x3
    v_mov_b32_dpp v215, v225 row_ror:8 row_mask:0xf bank_mask:0x3
    buffer_store_dwordx4 v[212:215], v97, s[32:35], s48 offen offset:128 sc1
    v_add3_u32 v227, v212, v213, v227
    v_add3_u32 v227, v214, v215, v227
    v_cvt_pk_bf16_f32 v220, v188, v204
    v_cvt_pk_bf16_f32 v221, v189, v205
    v_cvt_pk_bf16_f32 v222, v190, v206
    v_cvt_pk_bf16_f32 v223, v191, v207
    v_permlane16_swap_b32 v216, v217
    v_permlane16_swap_b32 v218, v219
    s_mov_b32 s48, 2097152
    v_mov_b32 v224, v216
    v_mov_b32 v225, v217
    v_mov_b32_dpp v216, v218 row_ror:8 row_mask:0xf bank_mask:0xc
    v_mov_b32_dpp v217, v219 row_ror:8 row_mask:0xf bank_mask:0xc
    v_mov_b32_dpp v218, v224 row_ror:8 row_mask:0xf bank_mask:0x3
    v_mov_b32_dpp v219, v225 row_ror:8 row_mask:0xf bank_mask:0x3
    buffer_store_dwordx4 v[216:219], v97, s[32:35], s48 offen offset:128 sc1
    v_add3_u32 v228, v216, v217, v228
    v_add3_u32 v228, v218, v219, v228
    v_permlane16_swap_b32 v220, v221
    v_permlane16_swap_b32 v222, v223
    s_mov_b32 s48, 3145728
    v_mov_b32 v224, v220
    v_mov_b32 v225, v221
    v_mov_b32_dpp v220, v222 row_ror:8 row_mask:0xf bank_mask:0xc
    v_mov_b32_dpp v221, v223 row_ror:8 row_mask:0xf bank_mask:0xc
    v_mov_b32_dpp v222, v224 row_ror:8 row_mask:0xf bank_mask:0x3
    v_mov_b32_dpp v223, v225 row_ror:8 row_mask:0xf bank_mask:0x3
    buffer_store_dwordx4 v[220:223], v97, s[32:35], s48 offen offset:128 sc1
    v_add3_u32 v229, v220, v221, v229
    v_add3_u32 v229, v222, v223, v229
    s_waitcnt lgkmcnt(0)
    v_add_f32 v8, v124, v125
    v_add_f32 v9, v126, v127
    v_add_f32 v141, v8, v9
    v_mov_b32 v143, v3
    v_add_u32_dpp v230, v226, v226 row_half_mirror row_mask:0xf bank_mask:0x5
    v_add_u32_dpp v231, v227, v227 row_half_mirror row_mask:0xf bank_mask:0x5
    s_nop 0
    v_add_u32_dpp v230, v228, v228 row_half_mirror row_mask:0xf bank_mask:0xa
    v_add_u32_dpp v231, v229, v229 row_half_mirror row_mask:0xf bank_mask:0xa
    v_max3_f32 v8, v232, v233, v234
    v_max_f32 v8, v8, v235
    v_add_u32_dpp v230, v230, v230 quad_perm:[1,0,3,2] row_mask:0xf bank_mask:0xf
    v_add_u32_dpp v231, v231, v231 quad_perm:[1,0,3,2] row_mask:0xf bank_mask:0xf
    s_nop 0
    v_add_u32_dpp v230, v230, v230 quad_perm:[2,3,0,1] row_mask:0xf bank_mask:0xf
    v_add_u32_dpp v231, v231, v231 quad_perm:[2,3,0,1] row_mask:0xf bank_mask:0xf
    v_mul_f32 v140, s46, v8
    v_cndmask_b32 v8, v230, v231, s[56:57]
    v_sub_u32 v142, v3, v8
    buffer_store_dwordx4 v[140:143], v64, s[32:35], 0 offen sc1
    s_waitcnt vmcnt(9)
    ds_write_b128 v100, a[0:3] offset:0
    ds_write_b128 v100, a[4:7] offset:1024
    ds_write_b128 v100, a[8:11] offset:2048
    ds_write_b128 v100, a[12:15] offset:3072
    ds_write_b128 v101, a[16:19] offset:4096
    ds_write_b128 v101, a[20:23] offset:5120
    ds_write_b128 v101, a[24:27] offset:6144
    ds_write_b128 v101, a[28:31] offset:7168
    s_lshl_b32 s6, s3, 16
    s_and_b32 s7, s4, 3
    s_lshl_b32 s7, s7, 9
    s_add_u32 s6, s6, s7
    s_lshr_b32 s7, s4, 2
    s_lshl_b32 s7, s7, 4
    s_add_u32 s6, s6, s7
    s_add_u32 s6, s6, 131072
    v_and_b32 v8, 31, v1
    v_lshl_add_u32 v68, v8, 11, s6
    s_lshl_b32 s7, s3, 9
    s_add_u32 s7, s7, 147456
    v_lshl_add_u32 v72, v8, 4, s7
    v_and_b32 v8, 1, v7
    v_lshl_or_b32 v8, v6, 1, v8
    v_lshl_or_b32 v8, v8, 2, v4
    v_lshl_add_u32 v96, v8, 4, s7
    v_lshlrev_b32 v8, 5, v4
    v_xor_b32 v70, v8, v2
    v_xor_b32 v71, 128, v70
    v_and_b32 v8, 1, v6
    v_lshrrev_b32 v9, 1, v6
    v_lshl_or_b32 v8, v8, 1, v9
    v_lshl_or_b32 v9, v8, 4, v4
    v_lshlrev_b32 v9, 8, v9
    v_lshl_or_b32 v9, v7, 3, v9
    v_and_b32 v10, 1, v4
    v_lshl_or_b32 v8, v8, 1, v10
    s_lshl_b32 s6, s3, 1
    v_xor_b32 v8, s6, v8
    v_lshl_or_b32 v74, v8, 5, v9
    v_xor_b32 v75, 32, v74
    v_lshl_or_b32 v9, v4, 3, v6
    v_lshlrev_b32 v9, 8, v9
    v_lshl_or_b32 v9, v7, 3, v9
    v_lshl_or_b32 v8, v10, 2, v6
    v_xor_b32 v8, s6, v8
    v_lshl_or_b32 v8, v8, 5, v9
    v_add_u32 v76, 32768, v8
    v_xor_b32 v77, 32, v76
    s_lshl_b32 s6, s4, 9
    s_add_u32 s6, s6, 393216
    v_lshl_add_u32 v8, v4, 4, s6
    v_lshl_add_u32 v78, v7, 7, v8
    v_lshl_or_b32 v8, v4, 2, v6
    v_mul_u32_u24 v8, 1152, v8
    s_mul_i32 s6, s3, 288
    s_add_u32 s6, s6, 65536
    v_lshl_add_u32 v9, v7, 3, s6
    v_add_u32 v79, v8, v9
    v_add_u32 v80, 147456, v2
    s_lshl_b32 s6, s3, 8
    s_add_u32 s6, s6, 149504
    v_lshl_add_u32 v81, v1, 1, s6
    v_lshl_add_u32 v82, v4, 4, s6
    s_lshl_b32 s6, s3, 6
    s_add_u32 s6, s6, 150528
    v_lshl_add_u32 v84, v4, 3, s6
    v_lshlrev_b32 v85, 4, v4
    v_add_u32 v85, 150528, v85
    s_lshl_b32 s64, s3, 13
    s_lshl_b32 s62, s4, 15
    s_add_u32 s62, s62, s64
    s_add_u32 s62, s62, 2097152
    s_add_u32 s64, s64, 32768
    s_mul_i32 s67, s3, 9216
    s_mul_i32 s65, s4, 36864
    s_add_u32 s65, s65, s67
    s_add_u32 s67, s67, 65536
    s_waitcnt lgkmcnt(0)
    v_cmp_eq_u32 s[52:53], 1, v4
    v_cmp_eq_u32 s[54:55], 2, v4
    s_barrier
    ds_read_b64_tr_b16 a[32:33], v74 offset:0
    ds_read_b64_tr_b16 a[34:35], v74 offset:2048
    ds_read_b64_tr_b16 a[36:37], v74 offset:1024
    ds_read_b64_tr_b16 a[38:39], v74 offset:3072
    ds_read_b64_tr_b16 a[40:41], v74 offset:16384
    ds_read_b64_tr_b16 a[42:43], v74 offset:18432
    ds_read_b64_tr_b16 a[44:45], v74 offset:17408
    ds_read_b64_tr_b16 a[46:47], v74 offset:19456
    ds_read_b64_tr_b16 a[48:49], v75 offset:0
    ds_read_b64_tr_b16 a[50:51], v75 offset:2048
    ds_read_b64_tr_b16 a[52:53], v75 offset:1024
    ds_read_b64_tr_b16 a[54:55], v75 offset:3072
    ds_read_b64_tr_b16 a[56:57], v75 offset:16384
    ds_read_b64_tr_b16 a[58:59], v75 offset:18432
    ds_read_b64_tr_b16 a[60:61], v75 offset:17408
    ds_read_b64_tr_b16 a[62:63], v75 offset:19456
    v_add_u32 v97, s64, v2
    s_waitcnt vmcnt(0)
    s_mov_b32 s47, 200000
L_r_9:
    buffer_load_dwordx4 v[88:91], v68, s[32:35], 0 offen sc1
    s_waitcnt vmcnt(0)
L_c_10:
    v_cmp_ne_u32 vcc, v91, v3
    s_nop 0
    s_cbranch_vccz L_o_11
    s_sub_u32 s47, s47, 1
    s_cmp_lg_u32 s47, 0
    s_cbranch_scc1 L_r_9
L_o_11:
    s_add_u32 m0, s64, 0
    s_add_u32 s48, s62, 0
    buffer_load_dwordx4 v70, s[32:35], s48 offen offset:0 sc1 lds
    buffer_load_dwordx4 v70, s[32:35], s48 offen offset:1024 sc1 lds
    buffer_load_dwordx4 v71, s[32:35], s48 offen offset:2048 sc1 lds
    buffer_load_dwordx4 v71, s[32:35], s48 offen offset:3072 sc1 lds
    s_add_u32 m0, s64, 4096
    s_add_u32 s48, s62, 4096
    buffer_load_dwordx4 v70, s[32:35], s48 offen offset:0 sc1 lds
    buffer_load_dwordx4 v70, s[32:35], s48 offen offset:1024 sc1 lds
    buffer_load_dwordx4 v71, s[32:35], s48 offen offset:2048 sc1 lds
    buffer_load_dwordx4 v71, s[32:35], s48 offen offset:3072 sc1 lds
    ds_write_b128 v72, v[88:91]
    s_waitcnt lgkmcnt(0)
    s_barrier
    ds_read_b64 v[88:89], v80
    ds_read_b64 v[92:93], v80 offset:1024
    ds_read_b32 v94, v96 offset:8
    s_add_u32 m0, s67, 0
    s_add_u32 s48, s65, 0
    buffer_load_dwordx4 v2, s[24:27], s48 offen offset:0 nt lds
    buffer_load_dwordx4 v2, s[24:27], s48 offen offset:1024 nt lds
    buffer_load_dwordx4 v2, s[24:27], s48 offen offset:2048 nt lds
    buffer_load_dwordx4 v2, s[24:27], s48 offen offset:3072 nt lds
    s_add_u32 m0, s67, 4096
    s_add_u32 s48, s65, 4096
    buffer_load_dwordx4 v2, s[24:27], s48 offen offset:0 nt lds
    buffer_load_dwordx4 v2, s[24:27], s48 offen offset:1024 nt lds
    buffer_load_dwordx4 v2, s[24:27], s48 offen offset:2048 nt lds
    buffer_load_dwordx4 v2, s[24:27], s48 offen offset:3072 nt lds
    s_add_u32 m0, s67, 8192
    s_add_u32 s48, s65, 8192
    buffer_load_dwordx4 v2, s[24:27], s48 offen offset:0 nt lds
    s_waitcnt lgkmcnt(0)
    v_max_f32 v8, v88, v92
    s_nop 1
    v_max_f32_dpp v8, v8, v8 row_ror:8 row_mask:0xf bank_mask:0xf
    s_nop 1
    v_max_f32_dpp v8, v8, v8 row_ror:4 row_mask:0xf bank_mask:0xf
    s_nop 1
    v_max_f32_dpp v8, v8, v8 row_ror:2 row_mask:0xf bank_mask:0xf
    s_nop 1
    v_max_f32_dpp v8, v8, v8 row_ror:1 row_mask:0xf bank_mask:0xf
    v_mov_b32 v9, v8
    s_nop 1
    v_permlane16_swap_b32 v8, v9
    v_max_f32 v8, v8, v9
    v_mov_b32 v9, v8
    s_nop 1
    v_permlane32_swap_b32 v8, v9
    v_max_f32 v8, v8, v9
    v_sub_f32 v88, v88, v8
    v_sub_f32 v92, v92, v8
    v_exp_f32 v88, v88
    v_exp_f32 v92, v92
    s_nop 0
    v_cvt_pk_bf16_f32 v8, v88, v92
    ds_write_b16 v81, v8
    ds_write_b16_d16_hi v81, v8 offset:128
    ds_read_b128 a[132:135], v82 offset:0
    ds_read_b128 a[136:139], v82 offset:64
    ds_read_b128 a[140:143], v82 offset:128
    ds_read_b128 a[144:147], v82 offset:192
    v_lshlrev_b32 v9, 16, v8
    v_and_b32 v10, 0xffff0000, v8
    v_mul_f32 v9, v9, v89
    v_fmac_f32 v9, v10, v93
    s_nop 1
    v_add_f32_dpp v9, v9, v9 row_ror:8 row_mask:0xf bank_mask:0xf
    s_nop 1
    v_add_f32_dpp v9, v9, v9 row_ror:4 row_mask:0xf bank_mask:0xf
    s_nop 1
    v_add_f32_dpp v9, v9, v9 row_ror:2 row_mask:0xf bank_mask:0xf
    s_nop 1
    v_add_f32_dpp v9, v9, v9 row_ror:1 row_mask:0xf bank_mask:0xf
    v_mov_b32 v10, v9
    s_nop 1
    v_permlane16_swap_b32 v9, v10
    v_add_f32 v9, v9, v10
    v_mov_b32 v10, v9
    s_nop 1
    v_permlane32_swap_b32 v9, v10
    v_add_f32 v9, v9, v10
    v_rcp_f32 v83, v9
    s_mov_b32 s47, 200000
    s_waitcnt vmcnt(9)
    s_branch L_c_13
L_r_12:
    s_add_u32 m0, s64, 0
    s_add_u32 s48, s62, 0
    buffer_load_dwordx4 v70, s[32:35], s48 offen offset:0 sc1 lds
    buffer_load_dwordx4 v70, s[32:35], s48 offen offset:1024 sc1 lds
    buffer_load_dwordx4 v71, s[32:35], s48 offen offset:2048 sc1 lds
    buffer_load_dwordx4 v71, s[32:35], s48 offen offset:3072 sc1 lds
    s_add_u32 m0, s64, 4096
    s_add_u32 s48, s62, 4096
    buffer_load_dwordx4 v70, s[32:35], s48 offen offset:0 sc1 lds
    buffer_load_dwordx4 v70, s[32:35], s48 offen offset:1024 sc1 lds
    buffer_load_dwordx4 v71, s[32:35], s48 offen offset:2048 sc1 lds
    buffer_load_dwordx4 v71, s[32:35], s48 offen offset:3072 sc1 lds
    s_waitcnt vmcnt(0)
L_c_13:
    ds_read_b128 v[100:103], v97 offset:0
    ds_read_b128 v[104:107], v97 offset:1024
    ds_read_b128 v[108:111], v97 offset:2048
    ds_read_b128 v[112:115], v97 offset:3072
    ds_read_b128 v[116:119], v97 offset:4096
    ds_read_b128 v[120:123], v97 offset:5120
    ds_read_b128 v[124:127], v97 offset:6144
    ds_read_b128 v[128:131], v97 offset:7168
    s_waitcnt lgkmcnt(7)
    v_add3_u32 v132, v100, v101, v102
    v_add_u32 v132, v132, v103
    s_waitcnt lgkmcnt(6)
    v_add3_u32 v133, v104, v105, v106
    v_add_u32 v133, v133, v107
    s_waitcnt lgkmcnt(5)
    v_add3_u32 v134, v108, v109, v110
    v_add_u32 v134, v134, v111
    s_waitcnt lgkmcnt(4)
    v_add3_u32 v135, v112, v113, v114
    v_add_u32 v135, v135, v115
    s_waitcnt lgkmcnt(3)
    v_add3_u32 v136, v116, v117, v118
    v_add_u32 v136, v136, v119
    s_waitcnt lgkmcnt(2)
    v_add3_u32 v137, v120, v121, v122
    v_add_u32 v137, v137, v123
    s_waitcnt lgkmcnt(1)
    v_add3_u32 v138, v124, v125, v126
    v_add_u32 v138, v138, v127
    s_waitcnt lgkmcnt(0)
    v_add3_u32 v139, v128, v129, v130
    v_add_u32 v139, v139, v131
    v_add_u32_dpp v140, v132, v132 row_ror:8 row_mask:0xf bank_mask:0x3
    v_add_u32_dpp v141, v133, v133 row_ror:8 row_mask:0xf bank_mask:0x3
    v_add_u32_dpp v142, v134, v134 row_ror:8 row_mask:0xf bank_mask:0x3
    v_add_u32_dpp v143, v135, v135 row_ror:8 row_mask:0xf bank_mask:0x3
    v_add_u32_dpp v140, v136, v136 row_ror:8 row_mask:0xf bank_mask:0xc
    v_add_u32_dpp v141, v137, v137 row_ror:8 row_mask:0xf bank_mask:0xc
    v_add_u32_dpp v142, v138, v138 row_ror:8 row_mask:0xf bank_mask:0xc
    v_add_u32_dpp v143, v139, v139 row_ror:8 row_mask:0xf bank_mask:0xc
    v_add_u32_dpp v132, v140, v140 row_half_mirror row_mask:0xf bank_mask:0x5
    v_add_u32_dpp v133, v141, v141 row_half_mirror row_mask:0xf bank_mask:0x5
    s_nop 0
    v_add_u32_dpp v132, v142, v142 row_half_mirror row_mask:0xf bank_mask:0xa
    v_add_u32_dpp v133, v143, v143 row_half_mirror row_mask:0xf bank_mask:0xa
    s_nop 0
    v_add_u32_dpp v132, v132, v132 quad_perm:[1,0,3,2] row_mask:0xf bank_mask:0xf
    v_add_u32_dpp v133, v133, v133 quad_perm:[1,0,3,2] row_mask:0xf bank_mask:0xf
    s_nop 0
    v_add_u32_dpp v132, v132, v132 quad_perm:[2,3,0,1] row_mask:0xf bank_mask:0xf
    v_add_u32_dpp v133, v133, v133 quad_perm:[2,3,0,1] row_mask:0xf bank_mask:0xf
    v_cndmask_b32 v8, v132, v133, s[56:57]
    v_add_u32 v8, v8, v94
    v_cmp_ne_u32 vcc, v8, v3
    s_nop 0
    s_cbranch_vccz L_o_14
    s_sub_u32 s47, s47, 1
    s_cmp_lg_u32 s47, 0
    s_cbranch_scc1 L_r_12
L_o_14:
    s_barrier
    ds_read_b64_tr_b16 a[100:101], v76 offset:0
    ds_read_b64_tr_b16 a[102:103], v76 offset:1024
    ds_read_b64_tr_b16 a[116:117], v77 offset:0
    ds_read_b64_tr_b16 a[118:119], v77 offset:1024
    ds_read_b64_tr_b16 a[104:105], v76 offset:8192
    ds_read_b64_tr_b16 a[106:107], v76 offset:9216
    ds_read_b64_tr_b16 a[120:121], v77 offset:8192
    ds_read_b64_tr_b16 a[122:123], v77 offset:9216
    ds_read_b64_tr_b16 a[108:109], v76 offset:16384
    ds_read_b64_tr_b16 a[110:111], v76 offset:17408
    ds_read_b64_tr_b16 a[124:125], v77 offset:16384
    ds_read_b64_tr_b16 a[126:127], v77 offset:17408
    ds_read_b64_tr_b16 a[112:113], v76 offset:24576
    ds_read_b64_tr_b16 a[114:115], v76 offset:25600
    ds_read_b64_tr_b16 a[128:129], v77 offset:24576
    ds_read_b64_tr_b16 a[130:131], v77 offset:25600
    s_waitcnt lgkmcnt(12)
    v_mfma_f32_16x16x32_bf16 v[100:103], a[100:103], a[132:135], 0
    v_mfma_f32_16x16x32_bf16 v[104:107], a[116:119], a[132:135], 0
    s_waitcnt lgkmcnt(8)
    v_mfma_f32_16x16x32_bf16 v[100:103], a[104:107], a[136:139], v[100:103]
    v_mfma_f32_16x16x32_bf16 v[104:107], a[120:123], a[136:139], v[104:107]
    s_waitcnt lgkmcnt(4)
    v_mfma_f32_16x16x32_bf16 v[100:103], a[108:111], a[140:143], v[100:103]
    v_mfma_f32_16x16x32_bf16 v[104:107], a[124:127], a[140:143], v[104:107]
    s_waitcnt lgkmcnt(0)
    v_mfma_f32_16x16x32_bf16 v[100:103], a[112:115], a[144:147], v[100:103]
    v_mfma_f32_16x16x32_bf16 v[104:107], a[128:131], a[144:147], v[104:107]
    s_nop 6
    v_mul_f32 v100, v100, v83
    v_mul_f32 v101, v101, v83
    v_mul_f32 v102, v102, v83
    v_mul_f32 v103, v103, v83
    v_mul_f32 v104, v104, v83
    v_mul_f32 v105, v105, v83
    v_mul_f32 v106, v106, v83
    v_mul_f32 v107, v107, v83
    v_cvt_pk_bf16_f32 v108, v100, v101
    v_cvt_pk_bf16_f32 v109, v102, v103
    v_cvt_pk_bf16_f32 v110, v104, v105
    v_cvt_pk_bf16_f32 v111, v106, v107
    ds_write_b64 v84, v[108:109]
    ds_write_b64 v84, v[110:111] offset:32
    s_waitcnt lgkmcnt(0)
    s_barrier
    ds_read_b128 a[148:151], v85 offset:0
    ds_read_b128 a[152:155], v85 offset:64
    ds_read_b128 a[156:159], v85 offset:128
    ds_read_b128 a[160:163], v85 offset:192
    s_waitcnt lgkmcnt(3)
    v_mfma_f32_16x16x32_bf16 v[112:115], a[32:35], a[148:151], 0
    v_mfma_f32_16x16x32_bf16 v[116:119], a[48:51], a[148:151], 0
    s_waitcnt lgkmcnt(2)
    v_mfma_f32_16x16x32_bf16 v[112:115], a[36:39], a[152:155], v[112:115]
    v_mfma_f32_16x16x32_bf16 v[116:119], a[52:55], a[152:155], v[116:119]
    s_waitcnt lgkmcnt(1)
    v_mfma_f32_16x16x32_bf16 v[112:115], a[40:43], a[156:159], v[112:115]
    v_mfma_f32_16x16x32_bf16 v[116:119], a[56:59], a[156:159], v[116:119]
    s_waitcnt lgkmcnt(0)
    v_mfma_f32_16x16x32_bf16 v[112:115], a[44:47], a[160:163], v[112:115]
    v_mfma_f32_16x16x32_bf16 v[116:119], a[60:63], a[160:163], v[116:119]
    s_nop 7
    v_cndmask_b32 v112, v112, v116, s[60:61]
    v_cndmask_b32 v113, v113, v117, s[60:61]
    v_cndmask_b32 v114, v114, v118, s[60:61]
    v_cndmask_b32 v115, v115, v119, s[60:61]
    v_perm_b32 v112, v112, v3, s40
    v_perm_b32 v113, v113, v3, s41
    v_perm_b32 v114, v114, v3, s42
    v_perm_b32 v115, v115, v3, s43
    buffer_store_dwordx4 v[112:115], v65, s[32:35], 0 offen sc1
    s_waitcnt vmcnt(0)
    buffer_load_dwordx4 v[120:123], v78, s[32:35], 0 offen offset:0 sc1
    buffer_load_dwordx4 v[124:127], v78, s[32:35], 0 offen offset:64 sc1
    s_barrier
    ds_read_b64_tr_b16 a[64:65], v79 offset:0
    ds_read_b64_tr_b16 a[66:67], v79 offset:18432
    ds_read_b64_tr_b16 a[68:69], v79 offset:32
    ds_read_b64_tr_b16 a[70:71], v79 offset:18464
    ds_read_b64_tr_b16 a[72:73], v79 offset:64
    ds_read_b64_tr_b16 a[74:75], v79 offset:18496
    ds_read_b64_tr_b16 a[76:77], v79 offset:96
    ds_read_b64_tr_b16 a[78:79], v79 offset:18528
    ds_read_b64_tr_b16 a[80:81], v79 offset:128
    ds_read_b64_tr_b16 a[82:83], v79 offset:18560
    ds_read_b64_tr_b16 a[84:85], v79 offset:160
    ds_read_b64_tr_b16 a[86:87], v79 offset:18592
    ds_read_b64_tr_b16 a[88:89], v79 offset:192
    ds_read_b64_tr_b16 a[90:91], v79 offset:18624
    ds_read_b64_tr_b16 a[92:93], v79 offset:224
    ds_read_b64_tr_b16 a[94:95], v79 offset:18656
    ds_read_b64_tr_b16 a[96:97], v79 offset:256
    ds_read_b64_tr_b16 a[98:99], v79 offset:18688
    s_mov_b32 s47, 200000
    s_waitcnt vmcnt(0)
    s_branch L_c_16
L_r_15:
    buffer_load_dwordx4 v[120:123], v78, s[32:35], 0 offen offset:0 sc1
    buffer_load_dwordx4 v[124:127], v78, s[32:35], 0 offen offset:64 sc1
    s_waitcnt vmcnt(0)
L_c_16:
    v_perm_b32 v9, v121, v120, s44
    v_perm_b32 v10, v123, v122, s45
    v_bitop3_b32 v8, v9, v10, v3 bitop3:0x56
    v_perm_b32 v9, v125, v124, s44
    v_perm_b32 v10, v127, v126, s45
    v_bitop3_b32 v9, v9, v10, v3 bitop3:0x56
    v_or_b32 v8, v8, v9
    v_cmp_ne_u32 vcc, 0, v8
    s_nop 0
    s_cbranch_vccz L_o_17
    s_sub_u32 s47, s47, 1
    s_cmp_lg_u32 s47, 0
    s_cbranch_scc1 L_r_15
L_o_17:
    v_and_b32 v120, s51, v120
    v_and_b32 v121, s51, v121
    v_and_b32 v122, s51, v122
    v_and_b32 v123, s51, v123
    v_and_b32 v124, s51, v124
    v_and_b32 v125, s51, v125
    v_and_b32 v126, s51, v126
    v_and_b32 v127, s51, v127
    v_add_f32_dpp v120, v120, v120 quad_perm:[1,0,3,2] row_mask:0xf bank_mask:0xf
    v_add_f32_dpp v121, v121, v121 quad_perm:[1,0,3,2] row_mask:0xf bank_mask:0xf
    v_add_f32_dpp v122, v122, v122 quad_perm:[1,0,3,2] row_mask:0xf bank_mask:0xf
    v_add_f32_dpp v123, v123, v123 quad_perm:[1,0,3,2] row_mask:0xf bank_mask:0xf
    v_add_f32_dpp v124, v124, v124 quad_perm:[1,0,3,2] row_mask:0xf bank_mask:0xf
    v_add_f32_dpp v125, v125, v125 quad_perm:[1,0,3,2] row_mask:0xf bank_mask:0xf
    v_add_f32_dpp v126, v126, v126 quad_perm:[1,0,3,2] row_mask:0xf bank_mask:0xf
    v_add_f32_dpp v127, v127, v127 quad_perm:[1,0,3,2] row_mask:0xf bank_mask:0xf
    v_add_f32_dpp v120, v120, v120 quad_perm:[2,3,0,1] row_mask:0xf bank_mask:0xf
    v_add_f32_dpp v121, v121, v121 quad_perm:[2,3,0,1] row_mask:0xf bank_mask:0xf
    v_add_f32_dpp v122, v122, v122 quad_perm:[2,3,0,1] row_mask:0xf bank_mask:0xf
    v_add_f32_dpp v123, v123, v123 quad_perm:[2,3,0,1] row_mask:0xf bank_mask:0xf
    v_add_f32_dpp v124, v124, v124 quad_perm:[2,3,0,1] row_mask:0xf bank_mask:0xf
    v_add_f32_dpp v125, v125, v125 quad_perm:[2,3,0,1] row_mask:0xf bank_mask:0xf
    v_add_f32_dpp v126, v126, v126 quad_perm:[2,3,0,1] row_mask:0xf bank_mask:0xf
    v_add_f32_dpp v127, v127, v127 quad_perm:[2,3,0,1] row_mask:0xf bank_mask:0xf
    v_cvt_pk_bf16_f32 v128, v120, v121
    v_cvt_pk_bf16_f32 v129, v122, v123
    v_cvt_pk_bf16_f32 v130, v124, v125
    v_cvt_pk_bf16_f32 v131, v126, v127
    s_waitcnt lgkmcnt(0)
    v_mov_b32 v171, v3
    v_mfma_f32_16x16x32_bf16 v[132:135], v[128:131], a[64:67], 0
    v_mfma_f32_16x16x32_bf16 v[144:147], v[128:131], a[76:79], 0
    v_mfma_f32_16x16x32_bf16 v[156:159], v[128:131], a[88:91], 0
    v_mfma_f32_16x16x32_bf16 v[136:139], v[128:131], a[68:71], 0
    v_mfma_f32_16x16x32_bf16 v[148:151], v[128:131], a[80:83], 0
    v_mfma_f32_16x16x32_bf16 v[160:163], v[128:131], a[92:95], 0
    v_mfma_f32_16x16x32_bf16 v[140:143], v[128:131], a[72:75], 0
    v_mfma_f32_16x16x32_bf16 v[152:155], v[128:131], a[84:87], 0
    v_mfma_f32_16x16x32_bf16 v[164:167], v[128:131], a[96:99], 0
    s_nop 0
    v_cndmask_b32 v168, v132, v144, s[52:53]
    v_cndmask_b32 v168, v168, v156, s[54:55]
    s_nop 0
    v_cndmask_b32 v169, v136, v148, s[52:53]
    v_cndmask_b32 v169, v169, v160, s[54:55]
    s_nop 0
    v_cndmask_b32 v170, v140, v152, s[52:53]
    v_cndmask_b32 v170, v170, v164, s[54:55]
    buffer_store_dwordx4 v[168:171], v13, s[32:35], 0 offen sc1
    s_and_b32 s50, s4, 63
    s_cmp_lt_u32 s50, 48
    s_cbranch_scc0 L_fdone_18
    s_cmp_lt_u32 s4, 64
    s_cselect_b32 s49, 524288, 0
    s_cselect_b32 s62, 0, 1152
    s_cselect_b32 s7, 0, 1048576
    s_add_u32 s49, s49, s7
    s_lshr_b32 s6, s50, 1
    s_lshl_b32 s6, s6, 14
    s_and_b32 s7, s50, 1
    s_lshl_b32 s7, s7, 6
    s_add_u32 s6, s6, s7
    s_lshl_b32 s7, s3, 12
    v_lshrrev_b32 v147, 2, v1
    v_lshlrev_b32 v147, 7, v147
    v_lshl_or_b32 v147, v7, 4, v147
    s_add_u32 s6, s6, s7
    s_add_u32 s48, s6, s49
    s_lshr_b32 s6, s50, 2
    s_mul_i32 s6, s6, 96
    s_and_b32 s7, s50, 3
    s_lshl_b32 s7, s7, 3
    s_add_u32 s6, s6, s7
    s_add_u32 s6, s6, s62
    v_lshl_add_u32 v8, v1, 1, s6
    v_cmp_gt_u32 vcc, 4, v1
    v_mov_b32 v11, 2130706432
    s_nop 0
    v_cndmask_b32 v140, v11, v8, vcc
    s_lshl_b32 s6, s3, 6
    s_add_u32 s6, s6, 151552
    v_lshl_add_u32 v145, v7, 4, s6
    v_lshlrev_b32 v146, 4, v5
    v_add_u32 v146, 151552, v146
    s_waitcnt vmcnt(0)
    s_mov_b32 s47, 200000
L_r_19:
    buffer_load_dwordx4 v[132:135], v147, s[32:35], s48 offen offset:0 sc1
    buffer_load_dwordx4 v[136:139], v147, s[32:35], s48 offen offset:2048 sc1
    s_waitcnt vmcnt(0)
L_c_20:
    v_bitop3_b32 v8, v135, v139, v3 bitop3:0x7e
    v_cmp_ne_u32 vcc, 0, v8
    s_nop 0
    s_cbranch_vccz L_o_21
    s_sub_u32 s47, s47, 1
    s_cmp_lg_u32 s47, 0
    s_cbranch_scc1 L_r_19
L_o_21:
    v_add_f32 v132, v132, v136
    v_add_f32 v133, v133, v137
    v_add_f32 v134, v134, v138
    v_add_f32_dpp v132, v132, v132 row_ror:4 row_mask:0xf bank_mask:0xf
    v_add_f32_dpp v133, v133, v133 row_ror:4 row_mask:0xf bank_mask:0xf
    v_add_f32_dpp v134, v134, v134 row_ror:4 row_mask:0xf bank_mask:0xf
    v_add_f32_dpp v132, v132, v132 row_ror:8 row_mask:0xf bank_mask:0xf
    v_add_f32_dpp v133, v133, v133 row_ror:8 row_mask:0xf bank_mask:0xf
    v_add_f32_dpp v134, v134, v134 row_ror:8 row_mask:0xf bank_mask:0xf
    v_mov_b32 v142, v132
    v_mov_b32 v143, v133
    v_mov_b32 v144, v134
    v_permlane16_swap_b32 v132, v142
    v_permlane16_swap_b32 v133, v143
    v_permlane16_swap_b32 v134, v144
    v_add_f32 v132, v132, v142
    v_add_f32 v133, v133, v143
    v_add_f32 v134, v134, v144
    v_mov_b32 v142, v132
    v_mov_b32 v143, v133
    v_mov_b32 v144, v134
    v_permlane32_swap_b32 v132, v142
    v_permlane32_swap_b32 v133, v143
    v_permlane32_swap_b32 v134, v144
    v_add_f32 v132, v132, v142
    v_add_f32 v133, v133, v143
    v_add_f32 v134, v134, v144
    ds_write_b128 v145, v[132:135]
    s_waitcnt lgkmcnt(0)
    s_barrier
    s_cmp_eq_u32 s3, 0
    s_cbranch_scc0 L_fdone_18
    ds_read_b128 v[132:135], v146
    s_waitcnt lgkmcnt(0)
    v_add_f32_dpp v132, v132, v132 row_ror:4 row_mask:0xf bank_mask:0xf
    v_add_f32_dpp v133, v133, v133 row_ror:4 row_mask:0xf bank_mask:0xf
    v_add_f32_dpp v134, v134, v134 row_ror:4 row_mask:0xf bank_mask:0xf
    v_add_f32_dpp v132, v132, v132 row_ror:8 row_mask:0xf bank_mask:0xf
    v_add_f32_dpp v133, v133, v133 row_ror:8 row_mask:0xf bank_mask:0xf
    v_add_f32_dpp v134, v134, v134 row_ror:8 row_mask:0xf bank_mask:0xf
    v_cvt_pk_bf16_f32 v132, v132, v132
    v_cvt_pk_bf16_f32 v133, v133, v133
    v_cvt_pk_bf16_f32 v134, v134, v134
    buffer_store_short v132, v140, s[36:39], 0 offen offset:0
    buffer_store_short v133, v140, s[36:39], 0 offen offset:32
    buffer_store_short v134, v140, s[36:39], 0 offen offset:64
    s_cmp_eq_u32 s4, 64
    s_cbranch_scc0 L_fdone_18
    v_cmp_eq_u32 vcc, 0, v1
    v_mov_b32 v11, 2130706432
    s_nop 0
    v_cndmask_b32 v9, v11, v1, vcc
    buffer_store_dword v3, v9, s[32:35], 0 offen sc1
L_fdone_18:
    s_endpgm
L_B_MAIN:
    v_lshrrev_b32 v4, 4, v1
    v_and_b32 v5, 15, v1
    v_bfe_u32 v6, v1, 2, 2
    v_and_b32 v7, 3, v1
    s_lshl_b32 s6, s4, 9
    s_add_u32 s6, s6, 458752
    v_lshl_add_u32 v8, v7, 7, s6
    s_lshl_b32 s6, s4, 8
    s_add_u32 s6, s6, 65536
    v_and_b32 v9, 1, v7
    v_lshl_add_u32 v9, v9, 7, s6
    v_cmp_eq_u32 vcc, 1, v6
    s_nop 1
    v_cndmask_b32 v8, v8, v9, vcc
    s_mul_i32 s6, s4, 80
    s_add_u32 s6, s6, 98304
    v_mov_b32 v9, s6
    v_cmp_lt_u32 vcc, 1, v6
    s_nop 1
    v_cndmask_b32 v8, v8, v9, vcc
    s_cmp_eq_u32 s3, 0
    s_cbranch_scc0 L_tw_22
    global_load_dword v12, v8, s[32:33]
L_tw_22:
    s_load_dword s5, s[32:33], 0
    s_load_dwordx2 s[28:29], s[0:1], 56
    s_load_dwordx2 s[20:21], s[0:1], 64
    s_load_dwordx2 s[24:25], s[0:1], 80
    s_mov_b32 s34, 16777216
    s_mov_b32 s35, 0x20000
    s_mov_b32 s30, 67108864
    s_mov_b32 s31, 0x20000
    s_mov_b32 s22, 67108864
    s_mov_b32 s23, 0x20000
    s_mov_b32 s26, 4718592
    s_mov_b32 s27, 0x20000
    s_mov_b32 s40, 0x07060500
    s_mov_b32 s41, 0x07060501
    s_mov_b32 s42, 0x07060502
    s_mov_b32 s43, 0x07060503
    s_mov_b32 s44, 0x0c0c0400
    s_mov_b32 s45, 0x04000c0c
    s_mov_b32 s46, 0x3e0293ee
    s_mov_b32 s51, 0xffffff00
    s_lshl_b32 s6, s4, 9
    s_lshl_b32 s7, s3, 7
    s_add_u32 s6, s6, s7
    s_add_u32 s6, s6, 917504
    v_lshl_add_u32 v8, v4, 4, s6
    v_lshl_add_u32 v8, v5, 6, v8
    v_cmp_gt_u32 vcc, 2, v5
    v_mov_b32 v11, 2130706432
    s_nop 0
    v_cndmask_b32 v18, v11, v8, vcc
    v_cmp_eq_u32 s[60:61], 1, v5
    v_lshlrev_b32 v20, 4, v4
    v_add_u32 v20, 125952, v20
    v_lshlrev_b32 v21, 3, v4
    v_add_u32 v21, 126208, v21
    v_and_b32 v10, 1, v4
    v_lshl_or_b32 v9, v10, 2, v6
    s_lshl_b32 s6, s3, 1
    v_xor_b32 v9, s6, v9
    v_lshlrev_b32 v9, 5, v9
    v_lshl_or_b32 v9, v7, 3, v9
    v_lshl_or_b32 v8, v4, 3, v6
    v_lshl_add_u32 v8, v8, 8, v9
    v_add_u32 v22, 126976, v8
    v_xor_b32 v23, 32, v22
    v_lshrrev_b32 v10, 1, v4
    v_lshl_or_b32 v9, v10, 2, v6
    v_xor_b32 v9, s6, v9
    v_lshlrev_b32 v9, 5, v9
    v_lshl_or_b32 v9, v7, 3, v9
    v_lshl_or_b32 v8, v4, 2, v6
    v_lshl_add_u32 v8, v8, 8, v9
    v_add_u32 v24, 159744, v8
    v_xor_b32 v25, 32, v24
    v_lshlrev_b32 v26, 6, v4
    v_lshl_or_b32 v26, v7, 4, v26
    buffer_load_dword v12, v18, s[32:35], 0 offen
    v_lshl_or_b32 v32, v6, 8, v26
    v_bfe_u32 v9, v5, 1, 2
    v_lshlrev_b32 v8, 7, v4
    v_lshl_or_b32 v8, v9, 5, v8
    v_lshrrev_b32 v9, 3, v5
    v_xor_b32 v9, v9, v5
    v_and_b32 v9, 1, v9
    v_lshl_or_b32 v8, v9, 11, v8
    s_lshr_b32 s6, s4, 3
    s_lshl_b32 s7, s6, 12
    s_add_u32 s7, s7, 917504
    v_add_u32 v19, s7, v8
    s_mul_i32 s63, s6, 3072
    s_and_b32 s63, s63, 32767
    s_lshl_b32 s6, s6, 22
    s_and_b32 s7, s4, 7
    s_lshl_b32 s7, s7, 2
    s_add_u32 s7, s7, s3
    s_lshr_b32 s49, s7, 0
    s_lshl_b32 s49, s49, 15
    s_add_u32 s6, s6, s49
    s_and_b32 s7, s7, 0
    s_lshl_b32 s7, s7, 10
    s_add_u32 s6, s6, s7
    s_add_u32 s62, s6, 3145728
    s_xor_b32 s49, s4, 0
    s_load_dwordx2 s[16:17], s[0:1], 8
    s_mov_b32 s18, 16777216
    s_mov_b32 s19, 0x20000
    s_lshl_b32 s6, s49, 2
    s_add_u32 s6, s6, s3
    s_lshr_b32 s7, s6, 2
    s_lshl_b32 s7, s7, 17
    s_and_b32 s6, s6, 3
    s_lshl_b32 s6, s6, 10
    s_add_u32 s6, s6, s7
    s_add_u32 s68, s6, 98304
    s_and_b32 s6, s49, 3
    s_lshl_b32 s6, s6, 2
    s_add_u32 s6, s6, s3
    s_lshl_b32 s6, s6, 18
    s_lshr_b32 s7, s49, 2
    s_lshl_b32 s7, s7, 8
    s_add_u32 s56, s6, s7
    v_lshlrev_b32 v40, 13, v4
    v_lshl_or_b32 v40, v5, 4, v40
    s_mul_i32 s6, s49, 36864
    s_add_u32 s57, s6, s59
    s_mov_b32 s49, 0x8000
    s_mul_i32 s64, s3, 24576
    v_and_b32 v8, 1, v4
    v_lshlrev_b32 v8, 5, v8
    v_xor_b32 v42, v8, v2
    v_xor_b32 v43, 64, v42
    v_xor_b32 v44, 128, v42
    v_xor_b32 v45, 192, v42
    s_lshr_b32 s6, s4, 2
    s_lshl_b32 s6, s6, 7
    s_and_b32 s7, s4, 3
    s_lshl_b32 s7, s7, 2
    s_add_u32 s6, s6, s7
    s_lshl_b32 s7, s3, 5
    s_add_u32 s6, s6, s7
    s_mul_i32 s65, s6, 1152
    s_add_u32 s66, s59, 126976
    v_lshrrev_b32 v8, 5, v1
    v_mul_u32_u24 v8, 13824, v8
    v_add_u32 v46, v8, v2
    v_lshl_or_b32 v8, v6, 2, v4
    v_lshlrev_b32 v8, 8, v8
    v_lshl_or_b32 v8, v7, 3, v8
    v_and_b32 v9, 1, v4
    v_lshl_or_b32 v9, v6, 1, v9
    v_lshl_or_b32 v8, v9, 5, v8
    v_xor_b32 v48, 0, v8
    v_xor_b32 v49, 32, v8
    v_xor_b32 v50, 64, v8
    v_xor_b32 v51, 96, v8
    v_xor_b32 v52, 128, v8
    v_xor_b32 v53, 160, v8
    v_xor_b32 v54, 192, v8
    v_xor_b32 v55, 224, v8
    v_add_u32 v48, s64, v48
    v_add_u32 v49, s64, v49
    v_add_u32 v50, s64, v50
    v_add_u32 v51, s64, v51
    v_add_u32 v52, s64, v52
    v_add_u32 v53, s64, v53
    v_add_u32 v54, s64, v54
    v_add_u32 v55, s64, v55
    s_lshr_b32 s6, s4, 3
    s_lshl_b32 s6, s6, 10
    s_and_b32 s7, s4, 7
    s_lshl_b32 s7, s7, 2
    s_add_u32 s7, s7, s3
    s_lshl_b32 s49, s7, 4
    s_add_u32 s6, s6, s49
    s_add_u32 s6, s6, 114688
    v_lshl_add_u32 v8, v1, 9, s6
    v_cmp_gt_u32 vcc, 2, v1
    v_mov_b32 v11, 2130706432
    s_nop 0
    v_cndmask_b32 v56, v11, v8, vcc
    s_lshr_b32 s6, s4, 3
    s_lshl_b32 s6, s6, 15
    s_lshl_b32 s49, s7, 7
    s_add_u32 s6, s6, s49
    s_add_u32 s6, s6, 1441792
    v_lshrrev_b32 v8, 1, v4
    v_lshl_or_b32 v8, v8, 2, v6
    v_lshlrev_b32 v8, 12, v8
    v_lshl_or_b32 v8, v7, 4, v8
    v_and_b32 v9, 1, v4
    v_lshl_or_b32 v8, v9, 6, v8
    v_add_u32 v57, s6, v8
    s_lshl_b32 s6, s4, 12
    s_add_u32 s6, s6, 1441792
    v_lshl_add_u32 v8, v5, 7, s6
    v_lshl_add_u32 v58, v4, 4, v8
    s_lshr_b32 s6, s4, 2
    s_lshl_b32 s6, s6, 9
    s_add_u32 s6, s6, 114688
    v_lshl_add_u32 v59, v5, 4, s6
    v_lshl_or_b32 v8, v6, 2, v4
    v_mul_u32_u24 v8, 1152, v8
    s_mul_i32 s6, s3, 288
    s_add_u32 s6, s6, 126976
    v_lshl_add_u32 v9, v7, 3, s6
    v_add_u32 v60, v8, v9
    v_lshlrev_b32 v61, 4, v4
    v_add_u32 v61, 98304, v61
    v_lshl_add_u32 v62, v6, 2, v61
    s_mul_i32 s6, s3, 6
    v_lshrrev_b32 v8, 3, v1
    v_add_u32 v8, s6, v8
    v_lshlrev_b32 v8, 14, v8
    v_and_b32 v9, 7, v1
    v_lshl_or_b32 v8, v9, 4, v8
    s_lshl_b32 s6, s4, 7
    s_add_u32 s6, s6, 1048576
    v_add_u32 v8, s6, v8
    v_cmp_gt_u32 vcc, 3, v4
    v_mov_b32 v11, 2130706432
    s_nop 0
    v_cndmask_b32 v13, v11, v8, vcc
    v_cmp_eq_u32 s[52:53], 1, v4
    v_cmp_eq_u32 s[54:55], 2, v4
    s_load_dwordx2 s[8:9], s[0:1], 32
    s_load_dwordx2 s[12:13], s[0:1], 40
    s_mov_b32 s10, 4194304
    s_mov_b32 s11, 0x20000
    s_mov_b32 s14, 4718592
    s_mov_b32 s15, 0x20000
    s_waitcnt lgkmcnt(0)
    s_mul_i32 s5, s5, 1664525
    s_add_u32 s5, s5, 1013904223
    v_mov_b32 v3, s5
    s_waitcnt vmcnt(5)
    s_add_u32 s67, s62, s63
    buffer_load_dwordx4 a[0:3], v32, s[28:31], s67 offen nt
    s_add_u32 s63, s63, 1024
    s_and_b32 s63, s63, 32767
    s_waitcnt vmcnt(8)
    buffer_load_dwordx4 v[36:39], v2, s[16:19], s68 offen
    s_waitcnt vmcnt(8)
    s_add_u32 s68, s68, 4096
    buffer_load_dwordx4 v[36:39], v2, s[16:19], s68 offen
    s_waitcnt vmcnt(8)
    s_add_u32 s68, s68, 4096
    buffer_load_dwordx4 v[36:39], v2, s[16:19], s68 offen
    s_waitcnt vmcnt(8)
    s_add_u32 s68, s68, 4096
    buffer_load_dwordx4 v[36:39], v2, s[16:19], s68 offen
    s_waitcnt vmcnt(8)
    s_add_u32 s68, s68, 4096
    buffer_load_dwordx4 v[36:39], v2, s[16:19], s68 offen
    s_waitcnt vmcnt(8)
    s_add_u32 s68, s68, 4096
    buffer_load_dwordx4 v[36:39], v2, s[16:19], s68 offen
    s_waitcnt vmcnt(8)
    s_barrier
    ds_read_b128 a[128:131], v20 offset:0
    ds_read_b64_tr_b16 a[148:149], v22 offset:0
    ds_read_b64_tr_b16 a[150:151], v22 offset:1024
    ds_read_b64_tr_b16 a[152:153], v23 offset:0
    ds_read_b64_tr_b16 a[154:155], v23 offset:1024
    ds_read_b128 a[132:135], v20 offset:64
    ds_read_b64_tr_b16 a[156:157], v22 offset:8192
    ds_read_b64_tr_b16 a[158:159], v22 offset:9216
    ds_read_b64_tr_b16 a[160:161], v23 offset:8192
    ds_read_b64_tr_b16 a[162:163], v23 offset:9216
    ds_read_b128 a[136:139], v20 offset:128
    ds_read_b64_tr_b16 a[164:165], v22 offset:16384
    ds_read_b64_tr_b16 a[166:167], v22 offset:17408
    ds_read_b64_tr_b16 a[168:169], v23 offset:16384
    ds_read_b64_tr_b16 a[170:171], v23 offset:17408
    s_waitcnt lgkmcnt(10)
    v_mfma_f32_16x16x32_bf16 v[64:67], a[148:151], a[128:131], 0
    v_mfma_f32_16x16x32_bf16 v[68:71], a[152:155], a[128:131], 0
    ds_read_b128 a[140:143], v20 offset:192
    ds_read_b64_tr_b16 a[172:173], v22 offset:24576
    ds_read_b64_tr_b16 a[174:175], v22 offset:25600
    ds_read_b64_tr_b16 a[176:177], v23 offset:24576
    ds_read_b64_tr_b16 a[178:179], v23 offset:25600
    s_waitcnt lgkmcnt(10)
    v_mfma_f32_16x16x32_bf16 v[64:67], a[156:159], a[132:135], v[64:67]
    v_mfma_f32_16x16x32_bf16 v[68:71], a[160:163], a[132:135], v[68:71]
    ds_read_b64 a[144:145], v21
    ds_read_b64_tr_b16 a[180:181], v24
    ds_read_b64_tr_b16 a[184:185], v25
    s_waitcnt lgkmcnt(8)
    v_mfma_f32_16x16x32_bf16 v[64:67], a[164:167], a[136:139], v[64:67]
    v_mfma_f32_16x16x32_bf16 v[68:71], a[168:171], a[136:139], v[68:71]
    s_waitcnt lgkmcnt(3)
    v_mfma_f32_16x16x32_bf16 v[64:67], a[172:175], a[140:143], v[64:67]
    v_mfma_f32_16x16x32_bf16 v[68:71], a[176:179], a[140:143], v[68:71]
    s_waitcnt lgkmcnt(0)
    v_mfma_f32_16x16x16_bf16 v[64:67], a[180:181], a[144:145], v[64:67]
    v_mfma_f32_16x16x16_bf16 v[68:71], a[184:185], a[144:145], v[68:71]
    s_nop 7
    v_cndmask_b32 v64, v64, v68, s[60:61]
    v_cndmask_b32 v65, v65, v69, s[60:61]
    v_cndmask_b32 v66, v66, v70, s[60:61]
    v_cndmask_b32 v67, v67, v71, s[60:61]
    v_perm_b32 v64, v64, v3, s40
    v_perm_b32 v65, v65, v3, s41
    v_perm_b32 v66, v66, v3, s42
    v_perm_b32 v67, v67, v3, s43
    buffer_store_dwordx4 v[64:67], v18, s[32:35], 0 offen sc1
    buffer_load_dword v12, v56, s[32:35], 0 offen
    buffer_load_dword v12, v13, s[32:35], 0 offen
    v_subrev_u32 v8, 524288, v13
    buffer_load_dword v12, v8, s[32:35], 0 offen
    s_lshl_b32 s6, s4, 11
    s_lshl_b32 s7, s3, 9
    s_add_u32 s6, s6, s7
    s_add_u32 s6, s6, 131072
    v_lshl_add_u32 v8, v7, 7, s6
    s_lshl_b32 s6, s4, 9
    s_lshl_b32 s7, s3, 7
    s_add_u32 s6, s6, s7
    s_add_u32 s6, s6, 393216
    v_mov_b32 v9, s6
    v_cmp_eq_u32 vcc, 1, v6
    s_nop 1
    v_cndmask_b32 v8, v8, v9, vcc
    v_lshlrev_b32 v9, 21, v7
    v_cmp_eq_u32 vcc, 2, v6
    s_nop 1
    v_cndmask_b32 v8, v8, v9, vcc
    buffer_load_dword v12, v8, s[32:35], 0 offen
    s_waitcnt vmcnt(13)
    s_add_u32 s68, s68, 4096
    buffer_load_dwordx4 v[36:39], v2, s[16:19], s68 offen
    s_waitcnt vmcnt(12)
    s_add_u32 s68, s68, 4096
    buffer_load_dwordx4 v[36:39], v2, s[16:19], s68 offen
    s_waitcnt vmcnt(12)
    s_add_u32 s67, s62, s63
    buffer_load_dwordx4 a[4:7], v32, s[28:31], s67 offen nt
    s_add_u32 s63, s63, 1024
    s_and_b32 s63, s63, 32767
    s_waitcnt vmcnt(12)
    s_add_u32 s67, s62, s63
    buffer_load_dwordx4 a[8:11], v32, s[28:31], s67 offen nt
    s_add_u32 s63, s63, 1024
    s_and_b32 s63, s63, 32767
    s_waitcnt vmcnt(12)
    s_add_u32 s67, s62, s63
    buffer_load_dwordx4 a[12:15], v32, s[28:31], s67 offen nt
    s_add_u32 s63, s63, 1024
    s_and_b32 s63, s63, 32767
    s_waitcnt vmcnt(12)
    s_add_u32 s67, s62, s63
    buffer_load_dwordx4 a[16:19], v32, s[28:31], s67 offen nt
    s_add_u32 s63, s63, 1024
    s_and_b32 s63, s63, 32767
    s_waitcnt vmcnt(12)
    s_add_u32 s67, s62, s63
    buffer_load_dwordx4 a[20:23], v32, s[28:31], s67 offen nt
    s_add_u32 s63, s63, 1024
    s_and_b32 s63, s63, 32767
    s_waitcnt vmcnt(12)
    s_add_u32 s67, s62, s63
    buffer_load_dwordx4 a[24:27], v32, s[28:31], s67 offen nt
    s_add_u32 s63, s63, 1024
    s_and_b32 s63, s63, 32767
    s_waitcnt vmcnt(7)
    s_add_u32 s67, s62, s63
    buffer_load_dwordx4 a[28:31], v32, s[28:31], s67 offen nt
    s_add_u32 s63, s63, 1024
    s_and_b32 s63, s63, 32767
    s_waitcnt vmcnt(4)
    s_add_u32 s67, s62, s63
    buffer_load_dwordx4 a[32:35], v32, s[28:31], s67 offen nt
    s_add_u32 s63, s63, 1024
    s_and_b32 s63, s63, 32767
    s_waitcnt vmcnt(4)
    s_add_u32 s67, s62, s63
    buffer_load_dwordx4 a[36:39], v32, s[28:31], s67 offen nt
    s_add_u32 s63, s63, 1024
    s_and_b32 s63, s63, 32767
    s_waitcnt vmcnt(4)
    s_add_u32 s67, s62, s63
    buffer_load_dwordx4 a[40:43], v32, s[28:31], s67 offen nt
    s_add_u32 s63, s63, 1024
    s_and_b32 s63, s63, 32767
    s_waitcnt vmcnt(4)
    s_add_u32 s67, s62, s63
    buffer_load_dwordx4 a[44:47], v32, s[28:31], s67 offen nt
    s_add_u32 s63, s63, 1024
    s_and_b32 s63, s63, 32767
    s_waitcnt vmcnt(4)
    s_add_u32 s67, s62, s63
    buffer_load_dwordx4 a[48:51], v32, s[28:31], s67 offen nt
    s_add_u32 s63, s63, 1024
    s_and_b32 s63, s63, 32767
    s_waitcnt vmcnt(4)
    s_add_u32 s67, s62, s63
    buffer_load_dwordx4 a[52:55], v32, s[28:31], s67 offen nt
    s_add_u32 s63, s63, 1024
    s_and_b32 s63, s63, 32767
    s_waitcnt vmcnt(4)
    s_add_u32 s67, s62, s63
    buffer_load_dwordx4 a[56:59], v32, s[28:31], s67 offen nt
    s_add_u32 s63, s63, 1024
    s_and_b32 s63, s63, 32767
    s_waitcnt vmcnt(4)
    s_add_u32 s67, s62, s63
    buffer_load_dwordx4 a[60:63], v32, s[28:31], s67 offen nt
    s_add_u32 s63, s63, 1024
    s_and_b32 s63, s63, 32767
    s_waitcnt vmcnt(4)
    s_add_u32 s67, s62, s63
    buffer_load_dwordx4 a[64:67], v32, s[28:31], s67 offen nt
    s_add_u32 s63, s63, 1024
    s_and_b32 s63, s63, 32767
    s_waitcnt vmcnt(4)
    s_add_u32 s67, s62, s63
    buffer_load_dwordx4 a[68:71], v32, s[28:31], s67 offen nt
    s_add_u32 s63, s63, 1024
    s_and_b32 s63, s63, 32767
    buffer_load_dwordx4 v[64:67], v19, s[32:35], 0 offen offset:0 sc1
    buffer_load_dwordx4 v[68:71], v19, s[32:35], 0 offen offset:16 sc1
    buffer_load_dwordx4 v[72:75], v19, s[32:35], 0 offen offset:512 sc1
    buffer_load_dwordx4 v[76:79], v19, s[32:35], 0 offen offset:528 sc1
    buffer_load_dwordx4 v[80:83], v19, s[32:35], 0 offen offset:1024 sc1
    buffer_load_dwordx4 v[84:87], v19, s[32:35], 0 offen offset:1040 sc1
    buffer_load_dwordx4 v[88:91], v19, s[32:35], 0 offen offset:1536 sc1
    buffer_load_dwordx4 v[92:95], v19, s[32:35], 0 offen offset:1552 sc1
    s_waitcnt vmcnt(12)
    s_add_u32 s67, s62, s63
    buffer_load_dwordx4 a[72:75], v32, s[28:31], s67 offen nt
    s_add_u32 s63, s63, 1024
    s_and_b32 s63, s63, 32767
    s_waitcnt vmcnt(12)
    s_add_u32 s67, s62, s63
    buffer_load_dwordx4 a[76:79], v32, s[28:31], s67 offen nt
    s_add_u32 s63, s63, 1024
    s_and_b32 s63, s63, 32767
    s_waitcnt vmcnt(12)
    s_add_u32 s67, s62, s63
    buffer_load_dwordx4 a[80:83], v32, s[28:31], s67 offen nt
    s_add_u32 s63, s63, 1024
    s_and_b32 s63, s63, 32767
    s_waitcnt vmcnt(12)
    s_add_u32 s67, s62, s63
    buffer_load_dwordx4 a[84:87], v32, s[28:31], s67 offen nt
    s_add_u32 s63, s63, 1024
    s_and_b32 s63, s63, 32767
    s_waitcnt vmcnt(12)
    s_add_u32 s67, s62, s63
    buffer_load_dwordx4 a[88:91], v32, s[28:31], s67 offen nt
    s_add_u32 s63, s63, 1024
    s_and_b32 s63, s63, 32767
    s_waitcnt vmcnt(4)
    s_add_u32 s67, s62, s63
    buffer_load_dwordx4 a[92:95], v32, s[28:31], s67 offen nt
    s_add_u32 s63, s63, 1024
    s_and_b32 s63, s63, 32767
    s_waitcnt vmcnt(15)
    s_add_u32 s67, s62, s63
    buffer_load_dwordx4 a[96:99], v32, s[28:31], s67 offen nt
    s_add_u32 s63, s63, 1024
    s_and_b32 s63, s63, 32767
    s_waitcnt vmcnt(15)
    s_add_u32 s67, s62, s63
    buffer_load_dwordx4 a[100:103], v32, s[28:31], s67 offen nt
    s_add_u32 s63, s63, 1024
    s_and_b32 s63, s63, 32767
    s_waitcnt vmcnt(7)
    s_add_u32 s67, s62, s63
    buffer_load_dwordx4 a[104:107], v32, s[28:31], s67 offen nt
    s_add_u32 s63, s63, 1024
    s_and_b32 s63, s63, 32767
    s_waitcnt vmcnt(7)
    s_add_u32 s67, s62, s63
    buffer_load_dwordx4 a[108:111], v32, s[28:31], s67 offen nt
    s_add_u32 s63, s63, 1024
    s_and_b32 s63, s63, 32767
    s_waitcnt vmcnt(7)
    s_add_u32 s67, s62, s63
    buffer_load_dwordx4 a[112:115], v32, s[28:31], s67 offen nt
    s_add_u32 s63, s63, 1024
    s_and_b32 s63, s63, 32767
    s_waitcnt vmcnt(7)
    s_add_u32 s67, s62, s63
    buffer_load_dwordx4 a[116:119], v32, s[28:31], s67 offen nt
    s_add_u32 s63, s63, 1024
    s_and_b32 s63, s63, 32767
    s_waitcnt vmcnt(7)
    s_add_u32 s67, s62, s63
    buffer_load_dwordx4 a[120:123], v32, s[28:31], s67 offen nt
    s_add_u32 s63, s63, 1024
    s_and_b32 s63, s63, 32767
    s_waitcnt vmcnt(7)
    s_add_u32 s67, s62, s63
    buffer_load_dwordx4 a[124:127], v32, s[28:31], s67 offen nt
    s_add_u32 s63, s63, 1024
    s_and_b32 s63, s63, 32767
    s_mov_b32 s47, 200000
    s_waitcnt vmcnt(14)
    s_branch L_c_24
L_r_23:
    buffer_load_dwordx4 v[64:67], v19, s[32:35], 0 offen offset:0 sc1
    buffer_load_dwordx4 v[68:71], v19, s[32:35], 0 offen offset:16 sc1
    buffer_load_dwordx4 v[72:75], v19, s[32:35], 0 offen offset:512 sc1
    buffer_load_dwordx4 v[76:79], v19, s[32:35], 0 offen offset:528 sc1
    buffer_load_dwordx4 v[80:83], v19, s[32:35], 0 offen offset:1024 sc1
    buffer_load_dwordx4 v[84:87], v19, s[32:35], 0 offen offset:1040 sc1
    buffer_load_dwordx4 v[88:91], v19, s[32:35], 0 offen offset:1536 sc1
    buffer_load_dwordx4 v[92:95], v19, s[32:35], 0 offen offset:1552 sc1
    s_waitcnt vmcnt(0)
L_c_24:
    v_perm_b32 v9, v65, v64, s44
    v_perm_b32 v10, v67, v66, s45
    v_bitop3_b32 v8, v9, v10, v3 bitop3:0x56
    v_perm_b32 v9, v69, v68, s44
    v_perm_b32 v10, v71, v70, s45
    v_bitop3_b32 v9, v9, v10, v3 bitop3:0x56
    v_or_b32 v8, v8, v9
    v_perm_b32 v9, v73, v72, s44
    v_perm_b32 v10, v75, v74, s45
    v_bitop3_b32 v9, v9, v10, v3 bitop3:0x56
    v_or_b32 v8, v8, v9
    v_perm_b32 v9, v77, v76, s44
    v_perm_b32 v10, v79, v78, s45
    v_bitop3_b32 v9, v9, v10, v3 bitop3:0x56
    v_or_b32 v8, v8, v9
    v_perm_b32 v9, v81, v80, s44
    v_perm_b32 v10, v83, v82, s45
    v_bitop3_b32 v9, v9, v10, v3 bitop3:0x56
    v_or_b32 v8, v8, v9
    v_perm_b32 v9, v85, v84, s44
    v_perm_b32 v10, v87, v86, s45
    v_bitop3_b32 v9, v9, v10, v3 bitop3:0x56
    v_or_b32 v8, v8, v9
    v_perm_b32 v9, v89, v88, s44
    v_perm_b32 v10, v91, v90, s45
    v_bitop3_b32 v9, v9, v10, v3 bitop3:0x56
    v_or_b32 v8, v8, v9
    v_perm_b32 v9, v93, v92, s44
    v_perm_b32 v10, v95, v94, s45
    v_bitop3_b32 v9, v9, v10, v3 bitop3:0x56
    v_or_b32 v8, v8, v9
    v_cmp_ne_u32 vcc, 0, v8
    s_nop 0
    s_cbranch_vccz L_o_25
    s_sub_u32 s47, s47, 1
    s_cmp_lg_u32 s47, 0
    s_cbranch_scc1 L_r_23
L_o_25:
    v_and_b32 v64, s51, v64
    v_and_b32 v65, s51, v65
    v_and_b32 v66, s51, v66
    v_and_b32 v67, s51, v67
    v_and_b32 v68, s51, v68
    v_and_b32 v69, s51, v69
    v_and_b32 v70, s51, v70
    v_and_b32 v71, s51, v71
    v_and_b32 v72, s51, v72
    v_and_b32 v73, s51, v73
    v_and_b32 v74, s51, v74
    v_and_b32 v75, s51, v75
    v_and_b32 v76, s51, v76
    v_and_b32 v77, s51, v77
    v_and_b32 v78, s51, v78
    v_and_b32 v79, s51, v79
    v_and_b32 v80, s51, v80
    v_and_b32 v81, s51, v81
    v_and_b32 v82, s51, v82
    v_and_b32 v83, s51, v83
    v_and_b32 v84, s51, v84
    v_and_b32 v85, s51, v85
    v_and_b32 v86, s51, v86
    v_and_b32 v87, s51, v87
    v_and_b32 v88, s51, v88
    v_and_b32 v89, s51, v89
    v_and_b32 v90, s51, v90
    v_and_b32 v91, s51, v91
    v_and_b32 v92, s51, v92
    v_and_b32 v93, s51, v93
    v_and_b32 v94, s51, v94
    v_and_b32 v95, s51, v95
    v_add_f32 v64, v64, v80
    v_add_f32 v65, v65, v81
    v_add_f32 v66, v66, v82
    v_add_f32 v67, v67, v83
    v_add_f32 v68, v68, v84
    v_add_f32 v69, v69, v85
    v_add_f32 v70, v70, v86
    v_add_f32 v71, v71, v87
    v_add_f32 v72, v72, v88
    v_add_f32 v73, v73, v89
    v_add_f32 v74, v74, v90
    v_add_f32 v75, v75, v91
    v_add_f32 v76, v76, v92
    v_add_f32 v77, v77, v93
    v_add_f32 v78, v78, v94
    v_add_f32 v79, v79, v95
    v_add_f32 v64, v64, v72
    v_add_f32 v65, v65, v73
    v_add_f32 v66, v66, v74
    v_add_f32 v67, v67, v75
    v_add_f32 v68, v68, v76
    v_add_f32 v69, v69, v77
    v_add_f32 v70, v70, v78
    v_add_f32 v71, v71, v79
    v_cvt_pk_bf16_f32 v28, v64, v65
    v_cvt_pk_bf16_f32 v29, v66, v67
    v_cvt_pk_bf16_f32 v30, v68, v69
    v_cvt_pk_bf16_f32 v31, v70, v71
    s_waitcnt vmcnt(7)
    s_add_u32 m0, s64, 0
    s_add_u32 s67, s62, s63
    buffer_load_dwordx4 v42, s[20:23], s67 offen nt lds
    s_add_u32 s63, s63, 1024
    s_and_b32 s63, s63, 32767
    s_waitcnt vmcnt(7)
    s_add_u32 m0, s64, 1024
    s_add_u32 s67, s62, s63
    buffer_load_dwordx4 v43, s[20:23], s67 offen nt lds
    s_add_u32 s63, s63, 1024
    s_and_b32 s63, s63, 32767
    s_waitcnt vmcnt(38)
    v_mfma_f32_16x16x32_bf16 v[96:99], a[0:3], v[28:31], 0
    v_mfma_f32_16x16x32_bf16 v[100:103], a[4:7], v[28:31], 0
    v_mfma_f32_16x16x32_bf16 v[104:107], a[8:11], v[28:31], 0
    v_mfma_f32_16x16x32_bf16 v[108:111], a[12:15], v[28:31], 0
    s_nop 4
    v_add_f32_dpp v64, v97, v96 row_shl:2 row_mask:0xf bank_mask:0xf
    v_add_f32_dpp v65, v101, v100 row_shl:2 row_mask:0xf bank_mask:0xf
    v_add_f32_dpp v66, v105, v104 row_shl:2 row_mask:0xf bank_mask:0xf
    v_add_f32_dpp v67, v109, v108 row_shl:2 row_mask:0xf bank_mask:0xf
    v_add_f32_dpp v64, v98, v64 row_shl:4 row_mask:0xf bank_mask:0xf
    v_add_f32_dpp v65, v102, v65 row_shl:4 row_mask:0xf bank_mask:0xf
    v_add_f32_dpp v66, v106, v66 row_shl:4 row_mask:0xf bank_mask:0xf
    v_add_f32_dpp v67, v110, v67 row_shl:4 row_mask:0xf bank_mask:0xf
    v_add_f32_dpp v64, v99, v64 row_shl:6 row_mask:0xf bank_mask:0xf
    v_add_f32_dpp v65, v103, v65 row_shl:6 row_mask:0xf bank_mask:0xf
    v_add_f32_dpp v66, v107, v66 row_shl:6 row_mask:0xf bank_mask:0xf
    v_add_f32_dpp v67, v111, v67 row_shl:6 row_mask:0xf bank_mask:0xf
    s_waitcnt vmcnt(7)
    s_add_u32 m0, s64, 2048
    s_add_u32 s67, s62, s63
    buffer_load_dwordx4 v44, s[20:23], s67 offen nt lds
    s_add_u32 s63, s63, 1024
    s_and_b32 s63, s63, 32767
    s_waitcnt vmcnt(35)
    v_mfma_f32_16x16x32_bf16 v[96:99], a[16:19], v[28:31], 0
    v_mfma_f32_16x16x32_bf16 v[100:103], a[20:23], v[28:31], 0
    v_mfma_f32_16x16x32_bf16 v[104:107], a[24:27], v[28:31], 0
    v_mfma_f32_16x16x32_bf16 v[108:111], a[28:31], v[28:31], 0
    s_nop 4
    v_add_f32_dpp v68, v97, v96 row_shl:2 row_mask:0xf bank_mask:0xf
    v_add_f32_dpp v69, v101, v100 row_shl:2 row_mask:0xf bank_mask:0xf
    v_add_f32_dpp v70, v105, v104 row_shl:2 row_mask:0xf bank_mask:0xf
    v_add_f32_dpp v71, v109, v108 row_shl:2 row_mask:0xf bank_mask:0xf
    v_add_f32_dpp v68, v98, v68 row_shl:4 row_mask:0xf bank_mask:0xf
    v_add_f32_dpp v69, v102, v69 row_shl:4 row_mask:0xf bank_mask:0xf
    v_add_f32_dpp v70, v106, v70 row_shl:4 row_mask:0xf bank_mask:0xf
    v_add_f32_dpp v71, v110, v71 row_shl:4 row_mask:0xf bank_mask:0xf
    v_add_f32_dpp v68, v99, v68 row_shl:6 row_mask:0xf bank_mask:0xf
    v_add_f32_dpp v69, v103, v69 row_shl:6 row_mask:0xf bank_mask:0xf
    v_add_f32_dpp v70, v107, v70 row_shl:6 row_mask:0xf bank_mask:0xf
    v_add_f32_dpp v71, v111, v71 row_shl:6 row_mask:0xf bank_mask:0xf
    s_waitcnt vmcnt(7)
    s_add_u32 m0, s64, 3072
    s_add_u32 s67, s62, s63
    buffer_load_dwordx4 v45, s[20:23], s67 offen nt lds
    s_add_u32 s63, s63, 1024
    s_and_b32 s63, s63, 32767
    s_waitcnt vmcnt(7)
    s_add_u32 m0, s64, 4096
    s_add_u32 s67, s62, s63
    buffer_load_dwordx4 v42, s[20:23], s67 offen nt lds
    s_add_u32 s63, s63, 1024
    s_and_b32 s63, s63, 32767
    s_waitcnt vmcnt(33)
    v_mfma_f32_16x16x32_bf16 v[96:99], a[32:35], v[28:31], 0
    v_mfma_f32_16x16x32_bf16 v[100:103], a[36:39], v[28:31], 0
    v_mfma_f32_16x16x32_bf16 v[104:107], a[40:43], v[28:31], 0
    v_mfma_f32_16x16x32_bf16 v[108:111], a[44:47], v[28:31], 0
    s_nop 4
    v_add_f32_dpp v72, v97, v96 row_shl:2 row_mask:0xf bank_mask:0xf
    v_add_f32_dpp v73, v101, v100 row_shl:2 row_mask:0xf bank_mask:0xf
    v_add_f32_dpp v74, v105, v104 row_shl:2 row_mask:0xf bank_mask:0xf
    v_add_f32_dpp v75, v109, v108 row_shl:2 row_mask:0xf bank_mask:0xf
    v_add_f32_dpp v72, v98, v72 row_shl:4 row_mask:0xf bank_mask:0xf
    v_add_f32_dpp v73, v102, v73 row_shl:4 row_mask:0xf bank_mask:0xf
    v_add_f32_dpp v74, v106, v74 row_shl:4 row_mask:0xf bank_mask:0xf
    v_add_f32_dpp v75, v110, v75 row_shl:4 row_mask:0xf bank_mask:0xf
    v_add_f32_dpp v72, v99, v72 row_shl:6 row_mask:0xf bank_mask:0xf
    v_add_f32_dpp v73, v103, v73 row_shl:6 row_mask:0xf bank_mask:0xf
    v_add_f32_dpp v74, v107, v74 row_shl:6 row_mask:0xf bank_mask:0xf
    v_add_f32_dpp v75, v111, v75 row_shl:6 row_mask:0xf bank_mask:0xf
    s_waitcnt vmcnt(7)
    s_add_u32 m0, s64, 5120
    s_add_u32 s67, s62, s63
    buffer_load_dwordx4 v43, s[20:23], s67 offen nt lds
    s_add_u32 s63, s63, 1024
    s_and_b32 s63, s63, 32767
    s_waitcnt vmcnt(30)
    v_mfma_f32_16x16x32_bf16 v[96:99], a[48:51], v[28:31], 0
    v_mfma_f32_16x16x32_bf16 v[100:103], a[52:55], v[28:31], 0
    v_mfma_f32_16x16x32_bf16 v[104:107], a[56:59], v[28:31], 0
    v_mfma_f32_16x16x32_bf16 v[108:111], a[60:63], v[28:31], 0
    s_nop 4
    v_add_f32_dpp v76, v97, v96 row_shl:2 row_mask:0xf bank_mask:0xf
    v_add_f32_dpp v77, v101, v100 row_shl:2 row_mask:0xf bank_mask:0xf
    v_add_f32_dpp v78, v105, v104 row_shl:2 row_mask:0xf bank_mask:0xf
    v_add_f32_dpp v79, v109, v108 row_shl:2 row_mask:0xf bank_mask:0xf
    v_add_f32_dpp v76, v98, v76 row_shl:4 row_mask:0xf bank_mask:0xf
    v_add_f32_dpp v77, v102, v77 row_shl:4 row_mask:0xf bank_mask:0xf
    v_add_f32_dpp v78, v106, v78 row_shl:4 row_mask:0xf bank_mask:0xf
    v_add_f32_dpp v79, v110, v79 row_shl:4 row_mask:0xf bank_mask:0xf
    v_add_f32_dpp v76, v99, v76 row_shl:6 row_mask:0xf bank_mask:0xf
    v_add_f32_dpp v77, v103, v77 row_shl:6 row_mask:0xf bank_mask:0xf
    v_add_f32_dpp v78, v107, v78 row_shl:6 row_mask:0xf bank_mask:0xf
    v_add_f32_dpp v79, v111, v79 row_shl:6 row_mask:0xf bank_mask:0xf
    s_waitcnt vmcnt(7)
    s_add_u32 m0, s64, 6144
    s_add_u32 s67, s62, s63
    buffer_load_dwordx4 v44, s[20:23], s67 offen nt lds
    s_add_u32 s63, s63, 1024
    s_and_b32 s63, s63, 32767
    s_waitcnt vmcnt(7)
    s_add_u32 m0, s64, 7168
    s_add_u32 s67, s62, s63
    buffer_load_dwordx4 v45, s[20:23], s67 offen nt lds
    s_add_u32 s63, s63, 1024
    s_and_b32 s63, s63, 32767
    s_waitcnt vmcnt(20)
    v_mfma_f32_16x16x32_bf16 v[96:99], a[64:67], v[28:31], 0
    v_mfma_f32_16x16x32_bf16 v[100:103], a[68:71], v[28:31], 0
    v_mfma_f32_16x16x32_bf16 v[104:107], a[72:75], v[28:31], 0
    v_mfma_f32_16x16x32_bf16 v[108:111], a[76:79], v[28:31], 0
    s_nop 4
    v_add_f32_dpp v80, v97, v96 row_shl:2 row_mask:0xf bank_mask:0xf
    v_add_f32_dpp v81, v101, v100 row_shl:2 row_mask:0xf bank_mask:0xf
    v_add_f32_dpp v82, v105, v104 row_shl:2 row_mask:0xf bank_mask:0xf
    v_add_f32_dpp v83, v109, v108 row_shl:2 row_mask:0xf bank_mask:0xf
    v_add_f32_dpp v80, v98, v80 row_shl:4 row_mask:0xf bank_mask:0xf
    v_add_f32_dpp v81, v102, v81 row_shl:4 row_mask:0xf bank_mask:0xf
    v_add_f32_dpp v82, v106, v82 row_shl:4 row_mask:0xf bank_mask:0xf
    v_add_f32_dpp v83, v110, v83 row_shl:4 row_mask:0xf bank_mask:0xf
    v_add_f32_dpp v80, v99, v80 row_shl:6 row_mask:0xf bank_mask:0xf
    v_add_f32_dpp v81, v103, v81 row_shl:6 row_mask:0xf bank_mask:0xf
    v_add_f32_dpp v82, v107, v82 row_shl:6 row_mask:0xf bank_mask:0xf
    v_add_f32_dpp v83, v111, v83 row_shl:6 row_mask:0xf bank_mask:0xf
    s_waitcnt vmcnt(7)
    s_add_u32 m0, s64, 8192
    s_add_u32 s67, s62, s63
    buffer_load_dwordx4 v42, s[20:23], s67 offen nt lds
    s_add_u32 s63, s63, 1024
    s_and_b32 s63, s63, 32767
    s_waitcnt vmcnt(17)
    v_mfma_f32_16x16x32_bf16 v[96:99], a[80:83], v[28:31], 0
    v_mfma_f32_16x16x32_bf16 v[100:103], a[84:87], v[28:31], 0
    v_mfma_f32_16x16x32_bf16 v[104:107], a[88:91], v[28:31], 0
    v_mfma_f32_16x16x32_bf16 v[108:111], a[92:95], v[28:31], 0
    s_nop 4
    v_add_f32_dpp v84, v97, v96 row_shl:2 row_mask:0xf bank_mask:0xf
    v_add_f32_dpp v85, v101, v100 row_shl:2 row_mask:0xf bank_mask:0xf
    v_add_f32_dpp v86, v105, v104 row_shl:2 row_mask:0xf bank_mask:0xf
    v_add_f32_dpp v87, v109, v108 row_shl:2 row_mask:0xf bank_mask:0xf
    v_add_f32_dpp v84, v98, v84 row_shl:4 row_mask:0xf bank_mask:0xf
    v_add_f32_dpp v85, v102, v85 row_shl:4 row_mask:0xf bank_mask:0xf
    v_add_f32_dpp v86, v106, v86 row_shl:4 row_mask:0xf bank_mask:0xf
    v_add_f32_dpp v87, v110, v87 row_shl:4 row_mask:0xf bank_mask:0xf
    v_add_f32_dpp v84, v99, v84 row_shl:6 row_mask:0xf bank_mask:0xf
    v_add_f32_dpp v85, v103, v85 row_shl:6 row_mask:0xf bank_mask:0xf
    v_add_f32_dpp v86, v107, v86 row_shl:6 row_mask:0xf bank_mask:0xf
    v_add_f32_dpp v87, v111, v87 row_shl:6 row_mask:0xf bank_mask:0xf
    s_waitcnt vmcnt(7)
    s_add_u32 m0, s64, 9216
    s_add_u32 s67, s62, s63
    buffer_load_dwordx4 v43, s[20:23], s67 offen nt lds
    s_add_u32 s63, s63, 1024
    s_and_b32 s63, s63, 32767
    s_waitcnt vmcnt(7)
    s_add_u32 m0, s64, 10240
    s_add_u32 s67, s62, s63
    buffer_load_dwordx4 v44, s[20:23], s67 offen nt lds
    s_add_u32 s63, s63, 1024
    s_and_b32 s63, s63, 32767
    s_waitcnt vmcnt(15)
    v_mfma_f32_16x16x32_bf16 v[96:99], a[96:99], v[28:31], 0
    v_mfma_f32_16x16x32_bf16 v[100:103], a[100:103], v[28:31], 0
    v_mfma_f32_16x16x32_bf16 v[104:107], a[104:107], v[28:31], 0
    v_mfma_f32_16x16x32_bf16 v[108:111], a[108:111], v[28:31], 0
    s_nop 4
    v_add_f32_dpp v88, v97, v96 row_shl:2 row_mask:0xf bank_mask:0xf
    v_add_f32_dpp v89, v101, v100 row_shl:2 row_mask:0xf bank_mask:0xf
    v_add_f32_dpp v90, v105, v104 row_shl:2 row_mask:0xf bank_mask:0xf
    v_add_f32_dpp v91, v109, v108 row_shl:2 row_mask:0xf bank_mask:0xf
    v_add_f32_dpp v88, v98, v88 row_shl:4 row_mask:0xf bank_mask:0xf
    v_add_f32_dpp v89, v102, v89 row_shl:4 row_mask:0xf bank_mask:0xf
    v_add_f32_dpp v90, v106, v90 row_shl:4 row_mask:0xf bank_mask:0xf
    v_add_f32_dpp v91, v110, v91 row_shl:4 row_mask:0xf bank_mask:0xf
    v_add_f32_dpp v88, v99, v88 row_shl:6 row_mask:0xf bank_mask:0xf
    v_add_f32_dpp v89, v103, v89 row_shl:6 row_mask:0xf bank_mask:0xf
    v_add_f32_dpp v90, v107, v90 row_shl:6 row_mask:0xf bank_mask:0xf
    v_add_f32_dpp v91, v111, v91 row_shl:6 row_mask:0xf bank_mask:0xf
    s_waitcnt vmcnt(7)
    s_add_u32 m0, s64, 11264
    s_add_u32 s67, s62, s63
    buffer_load_dwordx4 v45, s[20:23], s67 offen nt lds
    s_add_u32 s63, s63, 1024
    s_and_b32 s63, s63, 32767
    s_waitcnt vmcnt(12)
    v_mfma_f32_16x16x32_bf16 v[96:99], a[112:115], v[28:31], 0
    v_mfma_f32_16x16x32_bf16 v[100:103], a[116:119], v[28:31], 0
    v_mfma_f32_16x16x32_bf16 v[104:107], a[120:123], v[28:31], 0
    v_mfma_f32_16x16x32_bf16 v[108:111], a[124:127], v[28:31], 0
    s_nop 4
    v_add_f32_dpp v92, v97, v96 row_shl:2 row_mask:0xf bank_mask:0xf
    v_add_f32_dpp v93, v101, v100 row_shl:2 row_mask:0xf bank_mask:0xf
    v_add_f32_dpp v94, v105, v104 row_shl:2 row_mask:0xf bank_mask:0xf
    v_add_f32_dpp v95, v109, v108 row_shl:2 row_mask:0xf bank_mask:0xf
    v_add_f32_dpp v92, v98, v92 row_shl:4 row_mask:0xf bank_mask:0xf
    v_add_f32_dpp v93, v102, v93 row_shl:4 row_mask:0xf bank_mask:0xf
    v_add_f32_dpp v94, v106, v94 row_shl:4 row_mask:0xf bank_mask:0xf
    v_add_f32_dpp v95, v110, v95 row_shl:4 row_mask:0xf bank_mask:0xf
    v_add_f32_dpp v92, v99, v92 row_shl:6 row_mask:0xf bank_mask:0xf
    v_add_f32_dpp v93, v103, v93 row_shl:6 row_mask:0xf bank_mask:0xf
    v_add_f32_dpp v94, v107, v94 row_shl:6 row_mask:0xf bank_mask:0xf
    v_add_f32_dpp v95, v111, v95 row_shl:6 row_mask:0xf bank_mask:0xf
    v_max3_f32 v8, v64, v65, v66
    v_max3_f32 v9, v67, v68, v69
    v_max3_f32 v8, v8, v70, v71
    v_max3_f32 v9, v9, v72, v73
    v_max3_f32 v8, v8, v74, v75
    v_max3_f32 v9, v9, v76, v77
    v_max3_f32 v8, v8, v78, v79
    v_max3_f32 v9, v9, v80, v81
    v_max3_f32 v8, v8, v82, v83
    v_max3_f32 v9, v9, v84, v85
    v_max3_f32 v8, v8, v86, v87
    v_max3_f32 v9, v9, v88, v89
    v_max3_f32 v8, v8, v90, v91
    v_max3_f32 v9, v9, v92, v93
    v_max3_f32 v8, v8, v94, v95
    v_max_f32 v8, v8, v9
    s_waitcnt vmcnt(7)
    s_add_u32 m0, s64, 12288
    s_add_u32 s67, s62, s63
    buffer_load_dwordx4 v42, s[20:23], s67 offen nt lds
    s_add_u32 s63, s63, 1024
    s_and_b32 s63, s63, 32767
    v_mov_b32 v9, v8
    s_nop 1
    v_permlane16_swap_b32 v8, v9
    v_max_f32 v8, v8, v9
    v_mov_b32 v9, v8
    s_nop 1
    v_permlane32_swap_b32 v8, v9
    v_max_f32 v8, v8, v9
    v_mul_f32 v112, s46, v8
    v_fma_f32 v64, v64, s46, -v112
    v_fma_f32 v65, v65, s46, -v112
    v_fma_f32 v66, v66, s46, -v112
    v_fma_f32 v67, v67, s46, -v112
    v_fma_f32 v68, v68, s46, -v112
    v_fma_f32 v69, v69, s46, -v112
    v_fma_f32 v70, v70, s46, -v112
    v_fma_f32 v71, v71, s46, -v112
    s_waitcnt vmcnt(7)
    s_add_u32 m0, s64, 13312
    s_add_u32 s67, s62, s63
    buffer_load_dwordx4 v43, s[20:23], s67 offen nt lds
    s_add_u32 s63, s63, 1024
    s_and_b32 s63, s63, 32767
    v_exp_f32 v64, v64
    v_exp_f32 v65, v65
    v_exp_f32 v66, v66
    v_exp_f32 v67, v67
    v_exp_f32 v68, v68
    v_exp_f32 v69, v69
    v_exp_f32 v70, v70
    v_exp_f32 v71, v71
    v_cvt_pk_bf16_f32 v116, v64, v65
    v_cvt_pk_bf16_f32 v117, v66, v67
    v_cvt_pk_bf16_f32 v118, v68, v69
    v_cvt_pk_bf16_f32 v119, v70, v71
    s_waitcnt vmcnt(7)
    s_add_u32 m0, s64, 14336
    s_add_u32 s67, s62, s63
    buffer_load_dwordx4 v44, s[20:23], s67 offen nt lds
    s_add_u32 s63, s63, 1024
    s_and_b32 s63, s63, 32767
    v_fma_f32 v72, v72, s46, -v112
    v_fma_f32 v73, v73, s46, -v112
    v_fma_f32 v74, v74, s46, -v112
    v_fma_f32 v75, v75, s46, -v112
    v_fma_f32 v76, v76, s46, -v112
    v_fma_f32 v77, v77, s46, -v112
    v_fma_f32 v78, v78, s46, -v112
    v_fma_f32 v79, v79, s46, -v112
    s_waitcnt vmcnt(7)
    s_add_u32 m0, s64, 15360
    s_add_u32 s67, s62, s63
    buffer_load_dwordx4 v45, s[20:23], s67 offen nt lds
    s_add_u32 s63, s63, 1024
    s_and_b32 s63, s63, 32767
    v_exp_f32 v72, v72
    v_exp_f32 v73, v73
    v_exp_f32 v74, v74
    v_exp_f32 v75, v75
    v_exp_f32 v76, v76
    v_exp_f32 v77, v77
    v_exp_f32 v78, v78
    v_exp_f32 v79, v79
    v_cvt_pk_bf16_f32 v120, v72, v73
    v_cvt_pk_bf16_f32 v121, v74, v75
    v_cvt_pk_bf16_f32 v122, v76, v77
    v_cvt_pk_bf16_f32 v123, v78, v79
    s_waitcnt vmcnt(7)
    s_add_u32 m0, s64, 16384
    s_add_u32 s67, s62, s63
    buffer_load_dwordx4 v42, s[20:23], s67 offen nt lds
    s_add_u32 s63, s63, 1024
    s_and_b32 s63, s63, 32767
    v_fma_f32 v80, v80, s46, -v112
    v_fma_f32 v81, v81, s46, -v112
    v_fma_f32 v82, v82, s46, -v112
    v_fma_f32 v83, v83, s46, -v112
    v_fma_f32 v84, v84, s46, -v112
    v_fma_f32 v85, v85, s46, -v112
    v_fma_f32 v86, v86, s46, -v112
    v_fma_f32 v87, v87, s46, -v112
    s_waitcnt vmcnt(7)
    s_add_u32 m0, s64, 17408
    s_add_u32 s67, s62, s63
    buffer_load_dwordx4 v43, s[20:23], s67 offen nt lds
    s_add_u32 s63, s63, 1024
    s_and_b32 s63, s63, 32767
    v_exp_f32 v80, v80
    v_exp_f32 v81, v81
    v_exp_f32 v82, v82
    v_exp_f32 v83, v83
    v_exp_f32 v84, v84
    v_exp_f32 v85, v85
    v_exp_f32 v86, v86
    v_exp_f32 v87, v87
    v_cvt_pk_bf16_f32 v124, v80, v81
    v_cvt_pk_bf16_f32 v125, v82, v83
    v_cvt_pk_bf16_f32 v126, v84, v85
    v_cvt_pk_bf16_f32 v127, v86, v87
    s_waitcnt vmcnt(7)
    s_add_u32 m0, s64, 18432
    s_add_u32 s67, s62, s63
    buffer_load_dwordx4 v44, s[20:23], s67 offen nt lds
    s_add_u32 s63, s63, 1024
    s_and_b32 s63, s63, 32767
    v_fma_f32 v88, v88, s46, -v112
    v_fma_f32 v89, v89, s46, -v112
    v_fma_f32 v90, v90, s46, -v112
    v_fma_f32 v91, v91, s46, -v112
    v_fma_f32 v92, v92, s46, -v112
    v_fma_f32 v93, v93, s46, -v112
    v_fma_f32 v94, v94, s46, -v112
    v_fma_f32 v95, v95, s46, -v112
    s_waitcnt vmcnt(7)
    s_add_u32 m0, s64, 19456
    s_add_u32 s67, s62, s63
    buffer_load_dwordx4 v45, s[20:23], s67 offen nt lds
    s_add_u32 s63, s63, 1024
    s_and_b32 s63, s63, 32767
    v_exp_f32 v88, v88
    v_exp_f32 v89, v89
    v_exp_f32 v90, v90
    v_exp_f32 v91, v91
    v_exp_f32 v92, v92
    v_exp_f32 v93, v93
    v_exp_f32 v94, v94
    v_exp_f32 v95, v95
    v_cvt_pk_bf16_f32 v128, v88, v89
    v_cvt_pk_bf16_f32 v129, v90, v91
    v_cvt_pk_bf16_f32 v130, v92, v93
    v_cvt_pk_bf16_f32 v131, v94, v95
    s_waitcnt vmcnt(7)
    s_add_u32 m0, s64, 20480
    s_add_u32 s67, s62, s63
    buffer_load_dwordx4 v42, s[20:23], s67 offen nt lds
    s_add_u32 s63, s63, 1024
    s_and_b32 s63, s63, 32767
    v_add_f32 v64, v64, v80
    v_add_f32 v65, v65, v81
    v_add_f32 v66, v66, v82
    v_add_f32 v67, v67, v83
    v_add_f32 v68, v68, v84
    v_add_f32 v69, v69, v85
    v_add_f32 v70, v70, v86
    v_add_f32 v71, v71, v87
    v_add_f32 v72, v72, v88
    v_add_f32 v73, v73, v89
    v_add_f32 v74, v74, v90
    v_add_f32 v75, v75, v91
    v_add_f32 v76, v76, v92
    v_add_f32 v77, v77, v93
    v_add_f32 v78, v78, v94
    v_add_f32 v79, v79, v95
    s_waitcnt vmcnt(7)
    s_add_u32 m0, s64, 21504
    s_add_u32 s67, s62, s63
    buffer_load_dwordx4 v43, s[20:23], s67 offen nt lds
    s_add_u32 s63, s63, 1024
    s_and_b32 s63, s63, 32767
    v_add_f32 v64, v64, v72
    v_add_f32 v65, v65, v73
    v_add_f32 v66, v66, v74
    v_add_f32 v67, v67, v75
    v_add_f32 v68, v68, v76
    v_add_f32 v69, v69, v77
    v_add_f32 v70, v70, v78
    v_add_f32 v71, v71, v79
    s_waitcnt vmcnt(7)
    s_add_u32 m0, s64, 22528
    s_add_u32 s67, s62, s63
    buffer_load_dwordx4 v44, s[20:23], s67 offen nt lds
    s_add_u32 s63, s63, 1024
    s_and_b32 s63, s63, 32767
    v_add_f32 v64, v64, v68
    v_add_f32 v65, v65, v69
    v_add_f32 v66, v66, v70
    v_add_f32 v67, v67, v71
    v_add_f32 v64, v64, v66
    v_add_f32 v65, v65, v67
    v_add_f32 v64, v64, v65
    v_mov_b32 v9, v64
    s_nop 1
    v_permlane16_swap_b32 v64, v9
    v_add_f32 v64, v64, v9
    v_mov_b32 v9, v64
    s_nop 1
    v_permlane32_swap_b32 v64, v9
    v_add_f32 v64, v64, v9
    v_mov_b32 v113, v64
    v_mov_b32 v114, v3
    v_mov_b32 v115, v3
    buffer_store_dwordx4 v[112:115], v56, s[32:35], 0 offen sc1
    s_waitcnt vmcnt(8)
    s_add_u32 m0, s64, 23552
    s_add_u32 s67, s62, s63
    buffer_load_dwordx4 v45, s[20:23], s67 offen nt lds
    s_add_u32 s63, s63, 1024
    s_and_b32 s63, s63, 32767
    s_waitcnt vmcnt(17)
    ds_read_b64_tr_b16 a[128:129], v48 offset:0
    ds_read_b64_tr_b16 a[130:131], v48 offset:4096
    ds_read_b64_tr_b16 a[132:133], v49 offset:0
    ds_read_b64_tr_b16 a[134:135], v49 offset:4096
    ds_read_b64_tr_b16 a[136:137], v50 offset:0
    ds_read_b64_tr_b16 a[138:139], v50 offset:4096
    ds_read_b64_tr_b16 a[140:141], v51 offset:0
    ds_read_b64_tr_b16 a[142:143], v51 offset:4096
    ds_read_b64_tr_b16 a[144:145], v52 offset:0
    ds_read_b64_tr_b16 a[146:147], v52 offset:4096
    ds_read_b64_tr_b16 a[148:149], v53 offset:0
    ds_read_b64_tr_b16 a[150:151], v53 offset:4096
    ds_read_b64_tr_b16 a[152:153], v54 offset:0
    ds_read_b64_tr_b16 a[154:155], v54 offset:4096
    ds_read_b64_tr_b16 a[156:157], v55 offset:0
    ds_read_b64_tr_b16 a[158:159], v55 offset:4096
    s_waitcnt lgkmcnt(14)
    v_mfma_f32_16x16x32_bf16 v[132:135], v[116:119], a[128:131], 0
    s_waitcnt lgkmcnt(12)
    v_mfma_f32_16x16x32_bf16 v[136:139], v[116:119], a[132:135], 0
    s_waitcnt lgkmcnt(10)
    v_mfma_f32_16x16x32_bf16 v[140:143], v[116:119], a[136:139], 0
    s_waitcnt lgkmcnt(8)
    v_mfma_f32_16x16x32_bf16 v[144:147], v[116:119], a[140:143], 0
    s_waitcnt lgkmcnt(6)
    v_mfma_f32_16x16x32_bf16 v[148:151], v[116:119], a[144:147], 0
    s_waitcnt lgkmcnt(4)
    v_mfma_f32_16x16x32_bf16 v[152:155], v[116:119], a[148:151], 0
    s_waitcnt lgkmcnt(2)
    v_mfma_f32_16x16x32_bf16 v[156:159], v[116:119], a[152:155], 0
    s_waitcnt lgkmcnt(0)
    v_mfma_f32_16x16x32_bf16 v[160:163], v[116:119], a[156:159], 0
    s_waitcnt vmcnt(8)
    s_add_u32 m0, s64, 0
    s_add_u32 s67, s62, s63
    buffer_load_dwordx4 v42, s[20:23], s67 offen nt lds
    s_add_u32 s63, s63, 1024
    s_and_b32 s63, s63, 32767
    s_waitcnt vmcnt(10)
    ds_read_b64_tr_b16 a[128:129], v48 offset:8192
    ds_read_b64_tr_b16 a[130:131], v48 offset:12288
    ds_read_b64_tr_b16 a[132:133], v49 offset:8192
    ds_read_b64_tr_b16 a[134:135], v49 offset:12288
    ds_read_b64_tr_b16 a[136:137], v50 offset:8192
    ds_read_b64_tr_b16 a[138:139], v50 offset:12288
    ds_read_b64_tr_b16 a[140:141], v51 offset:8192
    ds_read_b64_tr_b16 a[142:143], v51 offset:12288
    ds_read_b64_tr_b16 a[144:145], v52 offset:8192
    ds_read_b64_tr_b16 a[146:147], v52 offset:12288
    ds_read_b64_tr_b16 a[148:149], v53 offset:8192
    ds_read_b64_tr_b16 a[150:151], v53 offset:12288
    ds_read_b64_tr_b16 a[152:153], v54 offset:8192
    ds_read_b64_tr_b16 a[154:155], v54 offset:12288
    ds_read_b64_tr_b16 a[156:157], v55 offset:8192
    ds_read_b64_tr_b16 a[158:159], v55 offset:12288
    s_waitcnt lgkmcnt(14)
    v_mfma_f32_16x16x32_bf16 v[132:135], v[120:123], a[128:131], v[132:135]
    s_waitcnt lgkmcnt(12)
    v_mfma_f32_16x16x32_bf16 v[136:139], v[120:123], a[132:135], v[136:139]
    s_waitcnt lgkmcnt(10)
    v_mfma_f32_16x16x32_bf16 v[140:143], v[120:123], a[136:139], v[140:143]
    s_waitcnt lgkmcnt(8)
    v_mfma_f32_16x16x32_bf16 v[144:147], v[120:123], a[140:143], v[144:147]
    s_waitcnt lgkmcnt(6)
    v_mfma_f32_16x16x32_bf16 v[148:151], v[120:123], a[144:147], v[148:151]
    s_waitcnt lgkmcnt(4)
    v_mfma_f32_16x16x32_bf16 v[152:155], v[120:123], a[148:151], v[152:155]
    s_waitcnt lgkmcnt(2)
    v_mfma_f32_16x16x32_bf16 v[156:159], v[120:123], a[152:155], v[156:159]
    s_waitcnt lgkmcnt(0)
    v_mfma_f32_16x16x32_bf16 v[160:163], v[120:123], a[156:159], v[160:163]
    s_waitcnt vmcnt(8)
    s_add_u32 m0, s64, 1024
    s_add_u32 s67, s62, s63
    buffer_load_dwordx4 v43, s[20:23], s67 offen nt lds
    s_add_u32 s63, s63, 1024
    s_and_b32 s63, s63, 32767
    s_waitcnt vmcnt(8)
    s_add_u32 m0, s64, 2048
    s_add_u32 s67, s62, s63
    buffer_load_dwordx4 v44, s[20:23], s67 offen nt lds
    s_add_u32 s63, s63, 1024
    s_and_b32 s63, s63, 32767
    s_waitcnt vmcnt(8)
    s_add_u32 m0, s64, 3072
    s_add_u32 s67, s62, s63
    buffer_load_dwordx4 v45, s[20:23], s67 offen nt lds
    s_add_u32 s63, s63, 1024
    s_and_b32 s63, s63, 32767
    s_waitcnt vmcnt(8)
    s_add_u32 m0, s64, 4096
    s_add_u32 s67, s62, s63
    buffer_load_dwordx4 v42, s[20:23], s67 offen nt lds
    s_add_u32 s63, s63, 1024
    s_and_b32 s63, s63, 32767
    s_waitcnt vmcnt(8)
    s_add_u32 m0, s64, 5120
    s_add_u32 s67, s62, s63
    buffer_load_dwordx4 v43, s[20:23], s67 offen nt lds
    s_add_u32 s63, s63, 1024
    s_and_b32 s63, s63, 32767
    s_waitcnt vmcnt(8)
    s_add_u32 m0, s64, 6144
    s_add_u32 s67, s62, s63
    buffer_load_dwordx4 v44, s[20:23], s67 offen nt lds
    s_add_u32 s63, s63, 1024
    s_and_b32 s63, s63, 32767
    s_waitcnt vmcnt(7)
    ds_read_b64_tr_b16 a[128:129], v48 offset:16384
    ds_read_b64_tr_b16 a[130:131], v48 offset:20480
    ds_read_b64_tr_b16 a[132:133], v49 offset:16384
    ds_read_b64_tr_b16 a[134:135], v49 offset:20480
    ds_read_b64_tr_b16 a[136:137], v50 offset:16384
    ds_read_b64_tr_b16 a[138:139], v50 offset:20480
    ds_read_b64_tr_b16 a[140:141], v51 offset:16384
    ds_read_b64_tr_b16 a[142:143], v51 offset:20480
    ds_read_b64_tr_b16 a[144:145], v52 offset:16384
    ds_read_b64_tr_b16 a[146:147], v52 offset:20480
    ds_read_b64_tr_b16 a[148:149], v53 offset:16384
    ds_read_b64_tr_b16 a[150:151], v53 offset:20480
    ds_read_b64_tr_b16 a[152:153], v54 offset:16384
    ds_read_b64_tr_b16 a[154:155], v54 offset:20480
    ds_read_b64_tr_b16 a[156:157], v55 offset:16384
    ds_read_b64_tr_b16 a[158:159], v55 offset:20480
    s_waitcnt lgkmcnt(14)
    v_mfma_f32_16x16x32_bf16 v[132:135], v[124:127], a[128:131], v[132:135]
    s_waitcnt lgkmcnt(12)
    v_mfma_f32_16x16x32_bf16 v[136:139], v[124:127], a[132:135], v[136:139]
    s_waitcnt lgkmcnt(10)
    v_mfma_f32_16x16x32_bf16 v[140:143], v[124:127], a[136:139], v[140:143]
    s_waitcnt lgkmcnt(8)
    v_mfma_f32_16x16x32_bf16 v[144:147], v[124:127], a[140:143], v[144:147]
    s_waitcnt lgkmcnt(6)
    v_mfma_f32_16x16x32_bf16 v[148:151], v[124:127], a[144:147], v[148:151]
    s_waitcnt lgkmcnt(4)
    v_mfma_f32_16x16x32_bf16 v[152:155], v[124:127], a[148:151], v[152:155]
    s_waitcnt lgkmcnt(2)
    v_mfma_f32_16x16x32_bf16 v[156:159], v[124:127], a[152:155], v[156:159]
    s_waitcnt lgkmcnt(0)
    v_mfma_f32_16x16x32_bf16 v[160:163], v[124:127], a[156:159], v[160:163]
    s_waitcnt vmcnt(7)
    s_add_u32 m0, s64, 7168
    s_add_u32 s67, s62, s63
    buffer_load_dwordx4 v45, s[20:23], s67 offen nt lds
    s_add_u32 s63, s63, 1024
    s_and_b32 s63, s63, 32767
    s_waitcnt vmcnt(7)
    s_add_u32 m0, s66, 0
    s_nop 0
    buffer_load_dwordx4 v2, s[24:27], s65 offen offset:0 nt lds
    s_waitcnt vmcnt(7)
    s_add_u32 m0, s66, 0
    s_nop 0
    buffer_load_dwordx4 v2, s[24:27], s65 offen offset:1024 nt lds
    s_waitcnt vmcnt(7)
    s_add_u32 m0, s66, 0
    s_nop 0
    buffer_load_dwordx4 v2, s[24:27], s65 offen offset:2048 nt lds
    s_waitcnt vmcnt(3)
    ds_read_b64_tr_b16 a[128:129], v48 offset:0
    ds_read_b64_tr_b16 a[130:131], v48 offset:4096
    ds_read_b64_tr_b16 a[132:133], v49 offset:0
    ds_read_b64_tr_b16 a[134:135], v49 offset:4096
    ds_read_b64_tr_b16 a[136:137], v50 offset:0
    ds_read_b64_tr_b16 a[138:139], v50 offset:4096
    ds_read_b64_tr_b16 a[140:141], v51 offset:0
    ds_read_b64_tr_b16 a[142:143], v51 offset:4096
    ds_read_b64_tr_b16 a[144:145], v52 offset:0
    ds_read_b64_tr_b16 a[146:147], v52 offset:4096
    ds_read_b64_tr_b16 a[148:149], v53 offset:0
    ds_read_b64_tr_b16 a[150:151], v53 offset:4096
    ds_read_b64_tr_b16 a[152:153], v54 offset:0
    ds_read_b64_tr_b16 a[154:155], v54 offset:4096
    ds_read_b64_tr_b16 a[156:157], v55 offset:0
    ds_read_b64_tr_b16 a[158:159], v55 offset:4096
    s_waitcnt lgkmcnt(14)
    v_mfma_f32_16x16x32_bf16 v[132:135], v[128:131], a[128:131], v[132:135]
    s_waitcnt lgkmcnt(12)
    v_mfma_f32_16x16x32_bf16 v[136:139], v[128:131], a[132:135], v[136:139]
    s_waitcnt lgkmcnt(10)
    v_mfma_f32_16x16x32_bf16 v[140:143], v[128:131], a[136:139], v[140:143]
    s_waitcnt lgkmcnt(8)
    v_mfma_f32_16x16x32_bf16 v[144:147], v[128:131], a[140:143], v[144:147]
    s_waitcnt lgkmcnt(6)
    v_mfma_f32_16x16x32_bf16 v[148:151], v[128:131], a[144:147], v[148:151]
    s_waitcnt lgkmcnt(4)
    v_mfma_f32_16x16x32_bf16 v[152:155], v[128:131], a[148:151], v[152:155]
    s_waitcnt lgkmcnt(2)
    v_mfma_f32_16x16x32_bf16 v[156:159], v[128:131], a[152:155], v[156:159]
    s_waitcnt lgkmcnt(0)
    v_mfma_f32_16x16x32_bf16 v[160:163], v[128:131], a[156:159], v[160:163]
    s_nop 1
    v_permlane16_swap_b32 v132, v148
    s_nop 0
    v_permlane16_swap_b32 v136, v152
    s_nop 0
    v_permlane16_swap_b32 v140, v156
    s_nop 0
    v_permlane16_swap_b32 v144, v160
    v_perm_b32 v164, v132, v3, s40
    v_perm_b32 v165, v136, v3, s41
    v_perm_b32 v166, v140, v3, s42
    v_perm_b32 v167, v144, v3, s43
    buffer_store_dwordx4 v[164:167], v57, s[32:35], 0 offen sc1
    s_add_u32 m0, s66, 0
    s_nop 0
    buffer_load_dwordx4 v2, s[24:27], s65 offen offset:3072 nt lds
    s_add_u32 s65, s65, 4096
    s_add_u32 m0, s66, 4096
    s_nop 0
    buffer_load_dwordx4 v46, s[24:27], s65 offen offset:0 nt lds
    s_add_u32 s65, s65, 13824
    s_add_u32 m0, s66, 4096
    s_nop 0
    buffer_load_dwordx4 v2, s[24:27], s65 offen offset:1024 nt lds
    s_add_u32 m0, s66, 4096
    s_nop 0
    buffer_load_dwordx4 v2, s[24:27], s65 offen offset:2048 nt lds
    s_add_u32 m0, s66, 4096
    s_nop 0
    buffer_load_dwordx4 v2, s[24:27], s65 offen offset:3072 nt lds
    s_add_u32 s65, s65, 4096
    s_add_u32 m0, s66, 8192
    s_nop 0
    buffer_load_dwordx4 v2, s[24:27], s65 offen offset:0 nt lds
    s_waitcnt vmcnt(0)
    s_barrier
    s_cmp_eq_u32 s3, 0
    s_cbranch_scc0 L_bskip_26
    s_mov_b32 s47, 200000
    buffer_load_dwordx4 v[188:191], v59, s[32:35], 0 offen offset:0 sc1
    buffer_load_dwordx4 v[192:195], v59, s[32:35], 0 offen offset:256 sc1
    buffer_load_dwordx4 v[172:175], v58, s[32:35], 0 offen offset:0 sc1
    buffer_load_dwordx4 v[176:179], v58, s[32:35], 0 offen offset:64 sc1
    buffer_load_dwordx4 v[180:183], v58, s[32:35], 0 offen offset:2048 sc1
    buffer_load_dwordx4 v[184:187], v58, s[32:35], 0 offen offset:2112 sc1
    ds_read_b64_tr_b16 a[160:161], v60 offset:0
    ds_read_b64_tr_b16 a[162:163], v60 offset:18432
    ds_read_b64_tr_b16 a[164:165], v60 offset:32
    ds_read_b64_tr_b16 a[166:167], v60 offset:18464
    ds_read_b64_tr_b16 a[168:169], v60 offset:64
    ds_read_b64_tr_b16 a[170:171], v60 offset:18496
    ds_read_b64_tr_b16 a[172:173], v60 offset:96
    ds_read_b64_tr_b16 a[174:175], v60 offset:18528
    ds_read_b64_tr_b16 a[176:177], v60 offset:128
    ds_read_b64_tr_b16 a[178:179], v60 offset:18560
    ds_read_b64_tr_b16 a[180:181], v60 offset:160
    ds_read_b64_tr_b16 a[182:183], v60 offset:18592
    ds_read_b64_tr_b16 a[184:185], v60 offset:192
    ds_read_b64_tr_b16 a[186:187], v60 offset:18624
    ds_read_b64_tr_b16 a[188:189], v60 offset:224
    ds_read_b64_tr_b16 a[190:191], v60 offset:18656
    ds_read_b64_tr_b16 a[192:193], v60 offset:256
    ds_read_b64_tr_b16 a[194:195], v60 offset:18688
    s_branch L_mf_30
L_mr_28:
    buffer_load_dwordx4 v[188:191], v59, s[32:35], 0 offen offset:0 sc1
    buffer_load_dwordx4 v[192:195], v59, s[32:35], 0 offen offset:256 sc1
    buffer_load_dwordx4 v[172:175], v58, s[32:35], 0 offen offset:0 sc1
    buffer_load_dwordx4 v[176:179], v58, s[32:35], 0 offen offset:64 sc1
    buffer_load_dwordx4 v[180:183], v58, s[32:35], 0 offen offset:2048 sc1
    buffer_load_dwordx4 v[184:187], v58, s[32:35], 0 offen offset:2112 sc1
L_mf_30:
    s_waitcnt vmcnt(4)
    v_max_f32 v8, v188, v192
    s_nop 1
    v_max_f32_dpp v8, v8, v8 row_ror:8 row_mask:0xf bank_mask:0xf
    s_nop 1
    v_max_f32_dpp v8, v8, v8 row_ror:4 row_mask:0xf bank_mask:0xf
    s_nop 1
    v_max_f32_dpp v8, v8, v8 row_ror:2 row_mask:0xf bank_mask:0xf
    s_nop 1
    v_max_f32_dpp v8, v8, v8 row_ror:1 row_mask:0xf bank_mask:0xf
    v_sub_f32 v188, v188, v8
    v_sub_f32 v192, v192, v8
    v_exp_f32 v188, v188
    v_exp_f32 v192, v192
    v_bitop3_b32 v191, v190, v194, v3 bitop3:0x7e
    v_mul_f32 v8, v188, v189
    v_fmac_f32 v8, v192, v193
    s_nop 1
    v_add_f32_dpp v8, v8, v8 row_ror:8 row_mask:0xf bank_mask:0xf
    s_nop 1
    v_add_f32_dpp v8, v8, v8 row_ror:4 row_mask:0xf bank_mask:0xf
    s_nop 1
    v_add_f32_dpp v8, v8, v8 row_ror:2 row_mask:0xf bank_mask:0xf
    s_nop 1
    v_add_f32_dpp v8, v8, v8 row_ror:1 row_mask:0xf bank_mask:0xf
    v_rcp_f32 v8, v8
    s_nop 0
    v_mul_f32 v188, v188, v8
    v_mul_f32 v192, v192, v8
    s_waitcnt vmcnt(0)
    v_perm_b32 v9, v173, v172, s44
    v_perm_b32 v10, v175, v174, s45
    v_bitop3_b32 v8, v9, v10, v3 bitop3:0x56
    v_perm_b32 v9, v177, v176, s44
    v_perm_b32 v10, v179, v178, s45
    v_bitop3_b32 v9, v9, v10, v3 bitop3:0x56
    v_or_b32 v8, v8, v9
    v_perm_b32 v9, v181, v180, s44
    v_perm_b32 v10, v183, v182, s45
    v_bitop3_b32 v9, v9, v10, v3 bitop3:0x56
    v_or_b32 v8, v8, v9
    v_perm_b32 v9, v185, v184, s44
    v_perm_b32 v10, v187, v186, s45
    v_bitop3_b32 v9, v9, v10, v3 bitop3:0x56
    v_or_b32 v8, v8, v9
    v_or_b32 v8, v8, v191
    v_cmp_ne_u32 vcc, 0, v8
    s_nop 0
    s_cbranch_vccz L_mo_29
    s_sub_u32 s47, s47, 1
    s_cmp_lg_u32 s47, 0
    s_cbranch_scc1 L_mr_28
L_mo_29:
    v_and_b32 v172, s51, v172
    v_and_b32 v173, s51, v173
    v_and_b32 v174, s51, v174
    v_and_b32 v175, s51, v175
    v_and_b32 v176, s51, v176
    v_and_b32 v177, s51, v177
    v_and_b32 v178, s51, v178
    v_and_b32 v179, s51, v179
    v_and_b32 v180, s51, v180
    v_and_b32 v181, s51, v181
    v_and_b32 v182, s51, v182
    v_and_b32 v183, s51, v183
    v_and_b32 v184, s51, v184
    v_and_b32 v185, s51, v185
    v_and_b32 v186, s51, v186
    v_and_b32 v187, s51, v187
    v_mul_f32 v172, v172, v188
    v_mul_f32 v173, v173, v188
    v_mul_f32 v174, v174, v188
    v_mul_f32 v175, v175, v188
    v_mul_f32 v176, v176, v188
    v_mul_f32 v177, v177, v188
    v_mul_f32 v178, v178, v188
    v_mul_f32 v179, v179, v188
    v_fmac_f32 v172, v180, v192
    v_fmac_f32 v173, v181, v192
    v_fmac_f32 v174, v182, v192
    v_fmac_f32 v175, v183, v192
    v_fmac_f32 v176, v184, v192
    v_fmac_f32 v177, v185, v192
    v_fmac_f32 v178, v186, v192
    v_fmac_f32 v179, v187, v192
    v_add_f32_dpp v180, v172, v172 row_ror:8 row_mask:0xf bank_mask:0x3
    v_add_f32_dpp v181, v173, v173 row_ror:8 row_mask:0xf bank_mask:0x3
    v_add_f32_dpp v182, v174, v174 row_ror:8 row_mask:0xf bank_mask:0x3
    v_add_f32_dpp v183, v175, v175 row_ror:8 row_mask:0xf bank_mask:0x3
    v_add_f32_dpp v180, v176, v176 row_ror:8 row_mask:0xf bank_mask:0xc
    v_add_f32_dpp v181, v177, v177 row_ror:8 row_mask:0xf bank_mask:0xc
    v_add_f32_dpp v182, v178, v178 row_ror:8 row_mask:0xf bank_mask:0xc
    v_add_f32_dpp v183, v179, v179 row_ror:8 row_mask:0xf bank_mask:0xc
    v_add_f32_dpp v172, v180, v180 row_half_mirror row_mask:0xf bank_mask:0x5
    v_add_f32_dpp v173, v181, v181 row_half_mirror row_mask:0xf bank_mask:0x5
    s_nop 0
    v_add_f32_dpp v172, v182, v182 row_half_mirror row_mask:0xf bank_mask:0xa
    v_add_f32_dpp v173, v183, v183 row_half_mirror row_mask:0xf bank_mask:0xa
    s_nop 0
    v_add_f32_dpp v172, v172, v172 quad_perm:[1,0,3,2] row_mask:0xf bank_mask:0xf
    v_add_f32_dpp v173, v173, v173 quad_perm:[1,0,3,2] row_mask:0xf bank_mask:0xf
    s_nop 0
    v_add_f32_dpp v172, v172, v172 quad_perm:[2,3,0,1] row_mask:0xf bank_mask:0xf
    v_add_f32_dpp v173, v173, v173 quad_perm:[2,3,0,1] row_mask:0xf bank_mask:0xf
    v_cvt_pk_bf16_f32 v8, v172, v173
    ds_write_b32 v62, v8
    s_branch L_bjoin_27
L_bskip_26:
    ds_read_b64_tr_b16 a[160:161], v60 offset:0
    ds_read_b64_tr_b16 a[162:163], v60 offset:18432
    ds_read_b64_tr_b16 a[164:165], v60 offset:32
    ds_read_b64_tr_b16 a[166:167], v60 offset:18464
    ds_read_b64_tr_b16 a[168:169], v60 offset:64
    ds_read_b64_tr_b16 a[170:171], v60 offset:18496
    ds_read_b64_tr_b16 a[172:173], v60 offset:96
    ds_read_b64_tr_b16 a[174:175], v60 offset:18528
    ds_read_b64_tr_b16 a[176:177], v60 offset:128
    ds_read_b64_tr_b16 a[178:179], v60 offset:18560
    ds_read_b64_tr_b16 a[180:181], v60 offset:160
    ds_read_b64_tr_b16 a[182:183], v60 offset:18592
    ds_read_b64_tr_b16 a[184:185], v60 offset:192
    ds_read_b64_tr_b16 a[186:187], v60 offset:18624
    ds_read_b64_tr_b16 a[188:189], v60 offset:224
    ds_read_b64_tr_b16 a[190:191], v60 offset:18656
    ds_read_b64_tr_b16 a[192:193], v60 offset:256
    ds_read_b64_tr_b16 a[194:195], v60 offset:18688
L_bjoin_27:
    s_waitcnt lgkmcnt(0)
    s_barrier
    ds_read_b128 v[168:171], v61
    s_waitcnt lgkmcnt(0)
    v_mov_b32 v235, v3
    v_mfma_f32_16x16x32_bf16 v[196:199], v[168:171], a[160:163], 0
    v_mfma_f32_16x16x32_bf16 v[208:211], v[168:171], a[172:175], 0
    v_mfma_f32_16x16x32_bf16 v[220:223], v[168:171], a[184:187], 0
    v_mfma_f32_16x16x32_bf16 v[200:203], v[168:171], a[164:167], 0
    v_mfma_f32_16x16x32_bf16 v[212:215], v[168:171], a[176:179], 0
    v_mfma_f32_16x16x32_bf16 v[224:227], v[168:171], a[188:191], 0
    v_mfma_f32_16x16x32_bf16 v[204:207], v[168:171], a[168:171], 0
    v_mfma_f32_16x16x32_bf16 v[216:219], v[168:171], a[180:183], 0
    v_mfma_f32_16x16x32_bf16 v[228:231], v[168:171], a[192:195], 0
    s_nop 0
    v_cndmask_b32 v232, v196, v208, s[52:53]
    v_cndmask_b32 v232, v232, v220, s[54:55]
    s_nop 0
    v_cndmask_b32 v233, v200, v212, s[52:53]
    v_cndmask_b32 v233, v233, v224, s[54:55]
    s_nop 0
    v_cndmask_b32 v234, v204, v216, s[52:53]
    v_cndmask_b32 v234, v234, v228, s[54:55]
    buffer_store_dwordx4 v[232:235], v13, s[32:35], 0 offen sc1
    s_endpgm
L_END:
    s_endpgm
L_CODE_END:
.section .rodata,"a"
.p2align 6
.amdhsa_kernel concat_heads__compressed_kv_cla__sliding_block_cached__decode_kernel
  .amdhsa_next_free_vgpr 432
  .amdhsa_next_free_sgpr 102
  .amdhsa_accum_offset 236
  .amdhsa_group_segment_fixed_size 0
  .amdhsa_kernarg_size 112
  .amdhsa_user_sgpr_count 2
  .amdhsa_user_sgpr_kernarg_segment_ptr 1
  .amdhsa_system_sgpr_workgroup_id_x 1
.end_amdhsa_kernel
```
